```python
import torch

def _softmax(x, axis=-1):
    return torch.softmax(x, dim=axis)
def _gelu(x):
    return torch.nn.functional.gelu(x, approximate="tanh")
def _silu(x):
    return torch.nn.functional.silu(x)
def _sigmoid(x):
    return torch.sigmoid(x)
def _layernorm(x, axis=-1, eps=1e-5):
    m = x.mean(dim=axis, keepdim=True)
    v = x.var(dim=axis, keepdim=True, unbiased=False)
    return (x - m) / torch.sqrt(v + eps)
def _scatter_add(tgt, idx, src, axis=0):
    return tgt.clone().index_add_(axis, idx, src)
def _segment_sum(src, seg, n):
    out = torch.zeros((n,) + src.shape[1:], dtype=src.dtype)
    return out.index_add_(0, seg, src)
def _pad(x, pw):
    flat = tuple(v for pair in reversed(pw) for v in pair)
    return torch.nn.functional.pad(x, flat)

kernel_name = 'standalone__ssm_conv_s4d__prompt'

def setup_inputs():

    _w = (lambda a: (lambda t: t.to(torch.bfloat16) if t.is_floating_point() else t)(torch.as_tensor(a)))
    Bsz, L, D, N = 1, 2048, 512, 128
    return {
        "u": _w((lambda *s: torch.randn(*s, dtype=torch.bfloat16) * 0.05)(Bsz, L, D)),
        "log_A_real": _w((lambda *s: torch.randn(*s, dtype=torch.bfloat16) * 6.4)(D, N) * 0.5),
        "A_imag": _w((lambda *s: torch.randn(*s, dtype=torch.bfloat16) * 0.05)(D, N) * 3.14),
        "C_real": _w((lambda *s: torch.randn(*s, dtype=torch.bfloat16) * 0.05)(D, N) / N ** 0.5),
        "C_imag": _w((lambda *s: torch.randn(*s, dtype=torch.bfloat16) * 0.05)(D, N) / N ** 0.5),
        "log_dt": _w((lambda *s: torch.randn(*s, dtype=torch.bfloat16) * 0.05)(D) * 0.5 - 4.0),
        "D_skip": _w((lambda *s: torch.randn(*s, dtype=torch.bfloat16) * 0.05)(D)),
    }

def reference(u, log_A_real, A_imag, C_real, C_imag, log_dt, D_skip):
    L = u.shape[1]
    dt = torch.exp(log_dt)
    A = -torch.exp(log_A_real) + 1j * A_imag
    C = (C_real + 1j * C_imag) * dt[:, None]
    pos = (lambda x, dt: x.to(dt))(torch.arange(L), log_dt.dtype)
    P = torch.exp((A * dt[:, None])[:, :, None] * pos[None, None, :])
    K = 2.0 * torch.einsum("dn,dnl->dl", C, P).real
    L2 = 2 * L
    u_t = (lambda x, *d: x.permute(*d))(u, 0, 2, 1)
    Kf = (lambda x, *a, **k: torch.fft.rfft(x.float(), *a, **k))(K, L2)
    Uf = (lambda x, *a, **k: torch.fft.rfft(x.float(), *a, **k))(u_t, L2)
    y = (lambda x, *a, **k: torch.fft.irfft(x, *a, **k).to(torch.bfloat16))(Uf * Kf[None, :, :], L2)[:, :, :L]
    y = (lambda x, *d: x.permute(*d))(y, 0, 2, 1)
    return y + u * D_skip[None, None, :]
```

```asm
; @launch grid=(256,1,1) block=(768,1,1) lds=163840
.amdgcn_target "amdgcn-amd-amdhsa--gfx950"
.text
.globl standalone__ssm_conv_s4d__prompt_kernel
.p2align 8
.type standalone__ssm_conv_s4d__prompt_kernel,@function
standalone__ssm_conv_s4d__prompt_kernel:
    s_load_dwordx16 s[8:23], s[0:1], 0
    s_cmp_ge_u32 s2, 256
    s_cbranch_scc1 L_end
    v_lshrrev_b32 v1, 6, v0
    v_and_b32 v0, 63, v0
    s_and_b32 s3, s2, 7
    s_lshr_b32 s4, s2, 3
    v_readfirstlane_b32 s5, v1
    s_and_b32 s6, s4, 15
    s_lshl_b32 s3, s3, 7
    s_lshl_b32 s6, s6, 3
    s_add_u32 s3, s3, s6
    s_lshr_b32 s7, s4, 4
    s_and_b32 s24, s5, 3
    s_lshl_b32 s25, s24, 1
    s_add_u32 s25, s25, s3
    s_lshl_b32 s26, s25, 7
    v_lshl_add_u32 v2, v0, 2, s26
    v_mov_b32 v3, s25
    s_mul_i32 s27, s24, 40960
    s_cmp_ge_u32 s5, 8
    s_cbranch_scc1 L_helper
    s_cmp_ge_u32 s5, 4
    s_cbranch_scc1 L_E
    v_mov_b32 v30, s27
    v_mov_b32 v31, 0
    ds_write_b32 v30, v31 offset:9000
    ds_write_b32 v31, v31 offset:9008
    s_waitcnt lgkmcnt(0)
    global_load_dword v4, v2, s[10:11]
    global_load_dword v5, v2, s[12:13]
    global_load_ushort v6, v3, s[18:19]
    global_load_ushort v7, v3, s[20:21]
    s_barrier
    s_branch L_F1
L_E:
    s_getpc_b64 s[38:39]
L_pc:
    s_sub_u32 s38, s38, L_pc-standalone__ssm_conv_s4d__prompt_kernel
    s_subb_u32 s39, s39, 0
    s_lshl_b32 s37, s24, 13
    v_lshl_add_u32 v10, v0, 7, s37
    v_min_u32 v10, L_codeend-standalone__ssm_conv_s4d__prompt_kernel-4, v10
    v_mov_b32 v11, s39
    v_add_co_u32 v10, vcc, s38, v10
    v_addc_co_u32 v11, vcc, 0, v11, vcc
    global_load_dword v12, v[10:11], off
    s_waitcnt lgkmcnt(0)
    global_load_dword v4, v2, s[10:11]
    global_load_dword v5, v2, s[12:13]
    global_load_ushort v6, v3, s[18:19]
    global_load_dword v7, v2, s[14:15]
    global_load_dword v8, v2, s[16:17]
    s_barrier
    s_branch L_E1
L_helper:
    s_lshr_b32 s37, s4, 2
    s_add_u32 s24, s24, s37
    s_and_b32 s24, s24, 3
    s_add_u32 s47, s4, s5
    s_and_b32 s47, s47, 3
    s_waitcnt lgkmcnt(0)
    s_mov_b32 s28, s8
    s_and_b32 s29, s9, 0xffff
    s_mov_b32 s30, 2097152
    s_mov_b32 s31, 0x00020000
    s_lshl_b32 s32, s24, 18
    v_lshl_add_u32 v10, v0, 12, s32
    s_sub_u32 s33, s32, 3072
    s_cmp_eq_u32 s24, 0
    s_cselect_b32 s34, 0x40000000, s33
    v_mov_b32 v11, 0x40000000
    v_mov_b32 v12, 0x40000000
    s_and_b32 s36, s7, s24
    s_lshr_b32 s37, s24, 1
    s_and_b32 s37, s37, s7
    s_or_b32 s36, s36, s37
    s_cmp_lg_u32 s36, 0
    s_cselect_b32 s35, 0x40000000, 0x100000
    s_add_u32 s33, s33, s35
    v_writelane_b32 v11, s34, 0
    v_writelane_b32 v12, s33, 0
    v_add_u32 v9, s35, v10
    s_add_u32 s38, s32, s3
    s_sub_u32 s38, s38, 3072
    s_max_i32 s39, s38, 0
    s_add_u32 s40, s8, s39
    s_addc_u32 s41, s9, 0
    s_add_u32 s38, s38, 0x100000
    s_add_u32 s42, s8, s38
    s_addc_u32 s43, s9, 0
    s_barrier
    s_load_dwordx2 s[72:73], s[42:43], 0
    s_load_dwordx2 s[74:75], s[42:43], 1024
    s_load_dwordx2 s[76:77], s[42:43], 2048
    s_cmp_eq_u32 s47, 1
    s_cbranch_scc1 L_re1
    s_cmp_eq_u32 s47, 2
    s_cbranch_scc1 L_re2
    s_cmp_eq_u32 s47, 3
    s_cbranch_scc1 L_re3
    buffer_load_dwordx2 v[102:103], v10, s[28:31], s3 offen offset:0 nt
    buffer_load_dwordx2 v[104:105], v10, s[28:31], s3 offen offset:1024 nt
    buffer_load_dwordx2 v[106:107], v10, s[28:31], s3 offen offset:2048 nt
    buffer_load_dwordx2 v[108:109], v10, s[28:31], s3 offen offset:3072 nt
    s_branch L_red
L_re1:
    buffer_load_dwordx2 v[104:105], v10, s[28:31], s3 offen offset:1024 nt
    buffer_load_dwordx2 v[106:107], v10, s[28:31], s3 offen offset:2048 nt
    buffer_load_dwordx2 v[108:109], v10, s[28:31], s3 offen offset:3072 nt
    buffer_load_dwordx2 v[102:103], v10, s[28:31], s3 offen offset:0 nt
    s_branch L_red
L_re2:
    buffer_load_dwordx2 v[106:107], v10, s[28:31], s3 offen offset:2048 nt
    buffer_load_dwordx2 v[108:109], v10, s[28:31], s3 offen offset:3072 nt
    buffer_load_dwordx2 v[102:103], v10, s[28:31], s3 offen offset:0 nt
    buffer_load_dwordx2 v[104:105], v10, s[28:31], s3 offen offset:1024 nt
    s_branch L_red
L_re3:
    buffer_load_dwordx2 v[108:109], v10, s[28:31], s3 offen offset:3072 nt
    buffer_load_dwordx2 v[102:103], v10, s[28:31], s3 offen offset:0 nt
    buffer_load_dwordx2 v[104:105], v10, s[28:31], s3 offen offset:1024 nt
    buffer_load_dwordx2 v[106:107], v10, s[28:31], s3 offen offset:2048 nt
L_red:
    s_branch L_L1
L_F1:
    v_mov_b32 v16, 0
    v_mov_b32 v17, 0
    v_mov_b32 v18, 0
    v_mov_b32 v19, 0
    v_min_u32 v10, 33, v0
    v_mul_u32_u24 v11, 2112, v10
    v_lshlrev_b32 v12, 4, v10
    v_add_u32 v12, 9264, v12
    v_cmp_gt_u32 vcc, 4, v10
    v_add_u32 v13, 16, v11
    v_mov_b32 v14, 24
    v_cndmask_b32 v11, v12, v11, vcc
    v_cndmask_b32 v13, v14, v13, vcc
    v_add_u32 v11, s27, v11
    v_add_u32 v13, s27, v13
    ds_write_b128 v11, v[16:19]
    ds_write_b64 v13, v[16:17]
    v_lshl_add_u32 v20, v0, 3, s27
    v_lshl_add_u32 v23, v0, 4, s27
    s_mov_b32 s32, 0xb1003210
    s_mov_b32 s33, 0x54bb5432
    s_mov_b32 s34, 0x98769876
    s_mov_b32 s35, 0xffeaddca
    s_mov_b32 s36, 0x100f0f70
    v_and_b32 v10, 31, v0
    v_lshlrev_b32 v11, 2, v10
    v_lshrrev_b64 v[12:13], v11, s[32:33]
    v_lshrrev_b64 v[14:15], v11, s[34:35]
    v_cmp_gt_u32 vcc, 16, v10
    v_lshrrev_b32 v13, v10, s36
    v_and_b32 v13, 1, v13
    v_cndmask_b32 v12, v14, v12, vcc
    v_and_b32 v12, 15, v12
    v_lshl_or_b32 v12, v13, 4, v12
    v_lshrrev_b32 v13, 5, v0
    v_lshl_add_u32 v13, v13, 4, s27
    s_movk_i32 s37, 528
    v_mad_u32_u24 v21, v12, s37, v13
    v_mad_u32_u24 v22, v10, s37, v13
    v_and_b32 v10, 15, v0
    v_lshrrev_b32 v11, 4, v0
    v_add_u32 v12, 1, v10
    v_and_b32 v13, 3, v12
    v_sub_u32 v12, v12, v13
    v_lshl_add_u32 v12, v11, 3, v12
    v_lshl_add_u32 v12, v12, 1, s27
    s_movk_i32 s37, 2112
    v_mad_u32_u24 v24, v13, s37, v12
    v_lshl_add_u32 v12, v11, 3, v10
    v_add_u32 v13, 11880, v24
    v_cmp_le_u32 vcc, 12, v12
    v_cmp_le_u32 s[38:39], 8, v12
    v_lshlrev_b32 v14, 1, v10
    v_sub_u32 v14, v14, v11
    v_cndmask_b32 v25, v24, v13, vcc
    v_cndmask_b32 v26, v24, v13, s[38:39]
    v_add_u32 v14, 3, v14
    v_lshl_add_u32 v27, v14, 4, s27
    s_lshl_b32 s37, s24, 6
    s_add_u32 s37, s37, s27
    v_mul_u32_u24 v14, 144, v11
    v_lshl_add_u32 v14, v10, 3, v14
    v_add_u32 v28, s37, v14
    v_and_b32 v14, 1, v0
    v_cmp_eq_u32 s[40:41], 1, v14
    v_cmp_eq_u32 s[42:43], 0, v0
    s_waitcnt vmcnt(0)
    s_setprio 1
    s_mov_b32 s44, 0x3fb8aa3b
    s_mov_b32 s45, 0x32a57060
    s_mov_b32 s46, 0x3f317218
    v_lshlrev_b32 v30, 16, v4
    v_and_b32 v31, 0xffff0000, v4
    v_lshlrev_b32 v34, 16, v6
    v_mul_f32 v35, s44, v30
    v_mul_f32 v36, s44, v31
    v_mul_f32 v37, s44, v34
    v_fma_f32 v38, v30, s44, -v35
    v_fma_f32 v39, v31, s44, -v36
    v_fma_f32 v40, v34, s44, -v37
    v_exp_f32 v35, v35
    v_exp_f32 v36, v36
    v_exp_f32 v37, v37
    v_fmac_f32 v38, s45, v30
    v_fmac_f32 v39, s45, v31
    v_fmac_f32 v40, s45, v34
    v_mul_f32 v38, s46, v38
    v_mul_f32 v39, s46, v39
    v_mul_f32 v40, s46, v40
    v_fmac_f32 v35, v35, v38
    v_fmac_f32 v36, v36, v39
    v_fmac_f32 v37, v37, v40
    v_cvt_pk_bf16_f32 v37, v37, v37
    v_cvt_pk_bf16_f32 v35, v35, v36
    v_lshlrev_b32 v32, 16, v5
    v_and_b32 v33, 0xffff0000, v5
    v_lshlrev_b32 v34, 16, v37
    v_lshlrev_b32 v30, 16, v35
    v_and_b32 v31, 0xffff0000, v35
    v_mul_f32 v30, v30, v34
    v_mul_f32 v31, v31, v34
    v_mul_f32 v32, v32, v34
    v_mul_f32 v33, v33, v34
    v_mul_f32 v30, 0xbfb8aa3b, v30
    v_mul_f32 v31, 0xbfb8aa3b, v31
    v_mul_f32 v32, 0.15915494, v32
    v_mul_f32 v33, 0.15915494, v33
    v_mul_f32 v36, 0x41000000, v30
    v_mul_f32 v37, 0x41000000, v32
    v_mul_f32 v38, 0x41000000, v31
    v_mul_f32 v39, 0x41000000, v33
    v_fract_f32 v37, v37
    v_fract_f32 v39, v39
    v_exp_f32 v36, v36
    v_exp_f32 v38, v38
    v_cos_f32 v52, v37
    v_sin_f32 v53, v37
    v_cos_f32 v54, v39
    v_sin_f32 v55, v39
    s_nop 0
    v_mul_f32 v52, v52, v36
    v_mul_f32 v53, v53, v36
    v_mul_f32 v54, v54, v38
    v_mul_f32 v55, v55, v38
    v_lshlrev_b32 v29, 16, v7
    s_nop 3
    v_cndmask_b32 v29, 0, v29, s[42:43]
    v_mov_b32 v44, 0x3f80
    v_mov_b32 v45, 0x3f80
    ds_write_b64 v20, v[44:45] offset:9808
    v_cvt_pk_bf16_f32 v46, v52, v53
    v_cvt_pk_bf16_f32 v47, v54, v55
    ds_write_b64 v20, v[46:47] offset:10336
    v_pk_mul_f32 v[56:57], v[52:53], v[52:53] op_sel_hi:[0,1]
    v_pk_mul_f32 v[58:59], v[54:55], v[54:55] op_sel_hi:[0,1]
    v_pk_fma_f32 v[56:57], v[52:53], v[52:53], v[56:57] op_sel:[1,1,0] op_sel_hi:[1,0,1] neg_lo:[1,0,0]
    v_pk_fma_f32 v[58:59], v[54:55], v[54:55], v[58:59] op_sel:[1,1,0] op_sel_hi:[1,0,1] neg_lo:[1,0,0]
    v_cvt_pk_bf16_f32 v48, v56, v57
    v_cvt_pk_bf16_f32 v49, v58, v59
    ds_write_b64 v20, v[48:49] offset:10864
    v_pk_mul_f32 v[60:61], v[56:57], v[52:53] op_sel_hi:[0,1]
    v_pk_mul_f32 v[62:63], v[58:59], v[54:55] op_sel_hi:[0,1]
    v_pk_fma_f32 v[60:61], v[56:57], v[52:53], v[60:61] op_sel:[1,1,0] op_sel_hi:[1,0,1] neg_lo:[1,0,0]
    v_pk_fma_f32 v[62:63], v[58:59], v[54:55], v[62:63] op_sel:[1,1,0] op_sel_hi:[1,0,1] neg_lo:[1,0,0]
    v_cvt_pk_bf16_f32 v44, v60, v61
    v_cvt_pk_bf16_f32 v45, v62, v63
    ds_write_b64 v20, v[44:45] offset:11392
    v_pk_mul_f32 v[56:57], v[60:61], v[52:53] op_sel_hi:[0,1]
    v_pk_mul_f32 v[58:59], v[62:63], v[54:55] op_sel_hi:[0,1]
    v_pk_fma_f32 v[56:57], v[60:61], v[52:53], v[56:57] op_sel:[1,1,0] op_sel_hi:[1,0,1] neg_lo:[1,0,0]
    v_pk_fma_f32 v[58:59], v[62:63], v[54:55], v[58:59] op_sel:[1,1,0] op_sel_hi:[1,0,1] neg_lo:[1,0,0]
    v_cvt_pk_bf16_f32 v46, v56, v57
    v_cvt_pk_bf16_f32 v47, v58, v59
    ds_write_b64 v20, v[46:47] offset:11920
    v_pk_mul_f32 v[60:61], v[56:57], v[52:53] op_sel_hi:[0,1]
    v_pk_mul_f32 v[62:63], v[58:59], v[54:55] op_sel_hi:[0,1]
    v_pk_fma_f32 v[60:61], v[56:57], v[52:53], v[60:61] op_sel:[1,1,0] op_sel_hi:[1,0,1] neg_lo:[1,0,0]
    v_pk_fma_f32 v[62:63], v[58:59], v[54:55], v[62:63] op_sel:[1,1,0] op_sel_hi:[1,0,1] neg_lo:[1,0,0]
    v_cvt_pk_bf16_f32 v48, v60, v61
    v_cvt_pk_bf16_f32 v49, v62, v63
    ds_write_b64 v20, v[48:49] offset:12448
    v_pk_mul_f32 v[56:57], v[60:61], v[52:53] op_sel_hi:[0,1]
    v_pk_mul_f32 v[58:59], v[62:63], v[54:55] op_sel_hi:[0,1]
    v_pk_fma_f32 v[56:57], v[60:61], v[52:53], v[56:57] op_sel:[1,1,0] op_sel_hi:[1,0,1] neg_lo:[1,0,0]
    v_pk_fma_f32 v[58:59], v[62:63], v[54:55], v[58:59] op_sel:[1,1,0] op_sel_hi:[1,0,1] neg_lo:[1,0,0]
    v_cvt_pk_bf16_f32 v44, v56, v57
    v_cvt_pk_bf16_f32 v45, v58, v59
    ds_write_b64 v20, v[44:45] offset:12976
    v_pk_mul_f32 v[60:61], v[56:57], v[52:53] op_sel_hi:[0,1]
    v_pk_mul_f32 v[62:63], v[58:59], v[54:55] op_sel_hi:[0,1]
    v_pk_fma_f32 v[60:61], v[56:57], v[52:53], v[60:61] op_sel:[1,1,0] op_sel_hi:[1,0,1] neg_lo:[1,0,0]
    v_pk_fma_f32 v[62:63], v[58:59], v[54:55], v[62:63] op_sel:[1,1,0] op_sel_hi:[1,0,1] neg_lo:[1,0,0]
    v_cvt_pk_bf16_f32 v46, v60, v61
    v_cvt_pk_bf16_f32 v47, v62, v63
    ds_write_b64 v20, v[46:47] offset:13504
    v_pk_mul_f32 v[56:57], v[60:61], v[52:53] op_sel_hi:[0,1]
    v_pk_mul_f32 v[58:59], v[62:63], v[54:55] op_sel_hi:[0,1]
    v_pk_fma_f32 v[56:57], v[60:61], v[52:53], v[56:57] op_sel:[1,1,0] op_sel_hi:[1,0,1] neg_lo:[1,0,0]
    v_pk_fma_f32 v[58:59], v[62:63], v[54:55], v[58:59] op_sel:[1,1,0] op_sel_hi:[1,0,1] neg_lo:[1,0,0]
    v_cvt_pk_bf16_f32 v48, v56, v57
    v_cvt_pk_bf16_f32 v49, v58, v59
    ds_write_b64 v20, v[48:49] offset:14032
    v_pk_mul_f32 v[60:61], v[56:57], v[52:53] op_sel_hi:[0,1]
    v_pk_mul_f32 v[62:63], v[58:59], v[54:55] op_sel_hi:[0,1]
    v_pk_fma_f32 v[60:61], v[56:57], v[52:53], v[60:61] op_sel:[1,1,0] op_sel_hi:[1,0,1] neg_lo:[1,0,0]
    v_pk_fma_f32 v[62:63], v[58:59], v[54:55], v[62:63] op_sel:[1,1,0] op_sel_hi:[1,0,1] neg_lo:[1,0,0]
    v_cvt_pk_bf16_f32 v44, v60, v61
    v_cvt_pk_bf16_f32 v45, v62, v63
    ds_write_b64 v20, v[44:45] offset:14560
    v_pk_mul_f32 v[56:57], v[60:61], v[52:53] op_sel_hi:[0,1]
    v_pk_mul_f32 v[58:59], v[62:63], v[54:55] op_sel_hi:[0,1]
    v_pk_fma_f32 v[56:57], v[60:61], v[52:53], v[56:57] op_sel:[1,1,0] op_sel_hi:[1,0,1] neg_lo:[1,0,0]
    v_pk_fma_f32 v[58:59], v[62:63], v[54:55], v[58:59] op_sel:[1,1,0] op_sel_hi:[1,0,1] neg_lo:[1,0,0]
    v_cvt_pk_bf16_f32 v46, v56, v57
    v_cvt_pk_bf16_f32 v47, v58, v59
    ds_write_b64 v20, v[46:47] offset:15088
    v_pk_mul_f32 v[60:61], v[56:57], v[52:53] op_sel_hi:[0,1]
    v_pk_mul_f32 v[62:63], v[58:59], v[54:55] op_sel_hi:[0,1]
    v_pk_fma_f32 v[60:61], v[56:57], v[52:53], v[60:61] op_sel:[1,1,0] op_sel_hi:[1,0,1] neg_lo:[1,0,0]
    v_pk_fma_f32 v[62:63], v[58:59], v[54:55], v[62:63] op_sel:[1,1,0] op_sel_hi:[1,0,1] neg_lo:[1,0,0]
    v_cvt_pk_bf16_f32 v48, v60, v61
    v_cvt_pk_bf16_f32 v49, v62, v63
    ds_write_b64 v20, v[48:49] offset:15616
    v_pk_mul_f32 v[56:57], v[60:61], v[52:53] op_sel_hi:[0,1]
    v_pk_mul_f32 v[58:59], v[62:63], v[54:55] op_sel_hi:[0,1]
    v_pk_fma_f32 v[56:57], v[60:61], v[52:53], v[56:57] op_sel:[1,1,0] op_sel_hi:[1,0,1] neg_lo:[1,0,0]
    v_pk_fma_f32 v[58:59], v[62:63], v[54:55], v[58:59] op_sel:[1,1,0] op_sel_hi:[1,0,1] neg_lo:[1,0,0]
    v_cvt_pk_bf16_f32 v44, v56, v57
    v_cvt_pk_bf16_f32 v45, v58, v59
    ds_write_b64 v20, v[44:45] offset:16144
    v_pk_mul_f32 v[60:61], v[56:57], v[52:53] op_sel_hi:[0,1]
    v_pk_mul_f32 v[62:63], v[58:59], v[54:55] op_sel_hi:[0,1]
    v_pk_fma_f32 v[60:61], v[56:57], v[52:53], v[60:61] op_sel:[1,1,0] op_sel_hi:[1,0,1] neg_lo:[1,0,0]
    v_pk_fma_f32 v[62:63], v[58:59], v[54:55], v[62:63] op_sel:[1,1,0] op_sel_hi:[1,0,1] neg_lo:[1,0,0]
    v_cvt_pk_bf16_f32 v46, v60, v61
    v_cvt_pk_bf16_f32 v47, v62, v63
    ds_write_b64 v20, v[46:47] offset:16672
    v_pk_mul_f32 v[56:57], v[60:61], v[52:53] op_sel_hi:[0,1]
    v_pk_mul_f32 v[58:59], v[62:63], v[54:55] op_sel_hi:[0,1]
    v_pk_fma_f32 v[56:57], v[60:61], v[52:53], v[56:57] op_sel:[1,1,0] op_sel_hi:[1,0,1] neg_lo:[1,0,0]
    v_pk_fma_f32 v[58:59], v[62:63], v[54:55], v[58:59] op_sel:[1,1,0] op_sel_hi:[1,0,1] neg_lo:[1,0,0]
    v_cvt_pk_bf16_f32 v48, v56, v57
    v_cvt_pk_bf16_f32 v49, v58, v59
    ds_write_b64 v20, v[48:49] offset:17200
    v_pk_mul_f32 v[60:61], v[56:57], v[52:53] op_sel_hi:[0,1]
    v_pk_mul_f32 v[62:63], v[58:59], v[54:55] op_sel_hi:[0,1]
    v_pk_fma_f32 v[60:61], v[56:57], v[52:53], v[60:61] op_sel:[1,1,0] op_sel_hi:[1,0,1] neg_lo:[1,0,0]
    v_pk_fma_f32 v[62:63], v[58:59], v[54:55], v[62:63] op_sel:[1,1,0] op_sel_hi:[1,0,1] neg_lo:[1,0,0]
    v_cvt_pk_bf16_f32 v44, v60, v61
    v_cvt_pk_bf16_f32 v45, v62, v63
    ds_write_b64 v20, v[44:45] offset:17728
    v_pk_mul_f32 v[56:57], v[60:61], v[52:53] op_sel_hi:[0,1]
    v_pk_mul_f32 v[58:59], v[62:63], v[54:55] op_sel_hi:[0,1]
    v_pk_fma_f32 v[56:57], v[60:61], v[52:53], v[56:57] op_sel:[1,1,0] op_sel_hi:[1,0,1] neg_lo:[1,0,0]
    v_pk_fma_f32 v[58:59], v[62:63], v[54:55], v[58:59] op_sel:[1,1,0] op_sel_hi:[1,0,1] neg_lo:[1,0,0]
    v_cvt_pk_bf16_f32 v46, v56, v57
    v_cvt_pk_bf16_f32 v47, v58, v59
    ds_write_b64 v20, v[46:47] offset:18256
    v_pk_mul_f32 v[60:61], v[56:57], v[52:53] op_sel_hi:[0,1]
    v_pk_mul_f32 v[62:63], v[58:59], v[54:55] op_sel_hi:[0,1]
    v_pk_fma_f32 v[60:61], v[56:57], v[52:53], v[60:61] op_sel:[1,1,0] op_sel_hi:[1,0,1] neg_lo:[1,0,0]
    v_pk_fma_f32 v[62:63], v[58:59], v[54:55], v[62:63] op_sel:[1,1,0] op_sel_hi:[1,0,1] neg_lo:[1,0,0]
    v_cvt_pk_bf16_f32 v48, v60, v61
    v_cvt_pk_bf16_f32 v49, v62, v63
    ds_write_b64 v20, v[48:49] offset:18784
    v_pk_mul_f32 v[56:57], v[60:61], v[52:53] op_sel_hi:[0,1]
    v_pk_mul_f32 v[58:59], v[62:63], v[54:55] op_sel_hi:[0,1]
    v_pk_fma_f32 v[56:57], v[60:61], v[52:53], v[56:57] op_sel:[1,1,0] op_sel_hi:[1,0,1] neg_lo:[1,0,0]
    v_pk_fma_f32 v[58:59], v[62:63], v[54:55], v[58:59] op_sel:[1,1,0] op_sel_hi:[1,0,1] neg_lo:[1,0,0]
    v_cvt_pk_bf16_f32 v44, v56, v57
    v_cvt_pk_bf16_f32 v45, v58, v59
    ds_write_b64 v20, v[44:45] offset:19312
    v_pk_mul_f32 v[60:61], v[56:57], v[52:53] op_sel_hi:[0,1]
    v_pk_mul_f32 v[62:63], v[58:59], v[54:55] op_sel_hi:[0,1]
    v_pk_fma_f32 v[60:61], v[56:57], v[52:53], v[60:61] op_sel:[1,1,0] op_sel_hi:[1,0,1] neg_lo:[1,0,0]
    v_pk_fma_f32 v[62:63], v[58:59], v[54:55], v[62:63] op_sel:[1,1,0] op_sel_hi:[1,0,1] neg_lo:[1,0,0]
    v_cvt_pk_bf16_f32 v46, v60, v61
    v_cvt_pk_bf16_f32 v47, v62, v63
    ds_write_b64 v20, v[46:47] offset:19840
    v_pk_mul_f32 v[56:57], v[60:61], v[52:53] op_sel_hi:[0,1]
    v_pk_mul_f32 v[58:59], v[62:63], v[54:55] op_sel_hi:[0,1]
    v_pk_fma_f32 v[56:57], v[60:61], v[52:53], v[56:57] op_sel:[1,1,0] op_sel_hi:[1,0,1] neg_lo:[1,0,0]
    v_pk_fma_f32 v[58:59], v[62:63], v[54:55], v[58:59] op_sel:[1,1,0] op_sel_hi:[1,0,1] neg_lo:[1,0,0]
    v_cvt_pk_bf16_f32 v48, v56, v57
    v_cvt_pk_bf16_f32 v49, v58, v59
    ds_write_b64 v20, v[48:49] offset:20368
    v_pk_mul_f32 v[60:61], v[56:57], v[52:53] op_sel_hi:[0,1]
    v_pk_mul_f32 v[62:63], v[58:59], v[54:55] op_sel_hi:[0,1]
    v_pk_fma_f32 v[60:61], v[56:57], v[52:53], v[60:61] op_sel:[1,1,0] op_sel_hi:[1,0,1] neg_lo:[1,0,0]
    v_pk_fma_f32 v[62:63], v[58:59], v[54:55], v[62:63] op_sel:[1,1,0] op_sel_hi:[1,0,1] neg_lo:[1,0,0]
    v_cvt_pk_bf16_f32 v44, v60, v61
    v_cvt_pk_bf16_f32 v45, v62, v63
    ds_write_b64 v20, v[44:45] offset:20896
    v_pk_mul_f32 v[56:57], v[60:61], v[52:53] op_sel_hi:[0,1]
    v_pk_mul_f32 v[58:59], v[62:63], v[54:55] op_sel_hi:[0,1]
    v_pk_fma_f32 v[56:57], v[60:61], v[52:53], v[56:57] op_sel:[1,1,0] op_sel_hi:[1,0,1] neg_lo:[1,0,0]
    v_pk_fma_f32 v[58:59], v[62:63], v[54:55], v[58:59] op_sel:[1,1,0] op_sel_hi:[1,0,1] neg_lo:[1,0,0]
    v_cvt_pk_bf16_f32 v46, v56, v57
    v_cvt_pk_bf16_f32 v47, v58, v59
    ds_write_b64 v20, v[46:47] offset:21424
    v_pk_mul_f32 v[60:61], v[56:57], v[52:53] op_sel_hi:[0,1]
    v_pk_mul_f32 v[62:63], v[58:59], v[54:55] op_sel_hi:[0,1]
    v_pk_fma_f32 v[60:61], v[56:57], v[52:53], v[60:61] op_sel:[1,1,0] op_sel_hi:[1,0,1] neg_lo:[1,0,0]
    v_pk_fma_f32 v[62:63], v[58:59], v[54:55], v[62:63] op_sel:[1,1,0] op_sel_hi:[1,0,1] neg_lo:[1,0,0]
    v_cvt_pk_bf16_f32 v48, v60, v61
    v_cvt_pk_bf16_f32 v49, v62, v63
    ds_write_b64 v20, v[48:49] offset:21952
    v_pk_mul_f32 v[56:57], v[60:61], v[52:53] op_sel_hi:[0,1]
    v_pk_mul_f32 v[58:59], v[62:63], v[54:55] op_sel_hi:[0,1]
    v_pk_fma_f32 v[56:57], v[60:61], v[52:53], v[56:57] op_sel:[1,1,0] op_sel_hi:[1,0,1] neg_lo:[1,0,0]
    v_pk_fma_f32 v[58:59], v[62:63], v[54:55], v[58:59] op_sel:[1,1,0] op_sel_hi:[1,0,1] neg_lo:[1,0,0]
    v_cvt_pk_bf16_f32 v44, v56, v57
    v_cvt_pk_bf16_f32 v45, v58, v59
    ds_write_b64 v20, v[44:45] offset:22480
    v_pk_mul_f32 v[60:61], v[56:57], v[52:53] op_sel_hi:[0,1]
    v_pk_mul_f32 v[62:63], v[58:59], v[54:55] op_sel_hi:[0,1]
    v_pk_fma_f32 v[60:61], v[56:57], v[52:53], v[60:61] op_sel:[1,1,0] op_sel_hi:[1,0,1] neg_lo:[1,0,0]
    v_pk_fma_f32 v[62:63], v[58:59], v[54:55], v[62:63] op_sel:[1,1,0] op_sel_hi:[1,0,1] neg_lo:[1,0,0]
    v_cvt_pk_bf16_f32 v46, v60, v61
    v_cvt_pk_bf16_f32 v47, v62, v63
    ds_write_b64 v20, v[46:47] offset:23008
    v_pk_mul_f32 v[56:57], v[60:61], v[52:53] op_sel_hi:[0,1]
    v_pk_mul_f32 v[58:59], v[62:63], v[54:55] op_sel_hi:[0,1]
    v_pk_fma_f32 v[56:57], v[60:61], v[52:53], v[56:57] op_sel:[1,1,0] op_sel_hi:[1,0,1] neg_lo:[1,0,0]
    v_pk_fma_f32 v[58:59], v[62:63], v[54:55], v[58:59] op_sel:[1,1,0] op_sel_hi:[1,0,1] neg_lo:[1,0,0]
    v_cvt_pk_bf16_f32 v48, v56, v57
    v_cvt_pk_bf16_f32 v49, v58, v59
    ds_write_b64 v20, v[48:49] offset:23536
    v_pk_mul_f32 v[60:61], v[56:57], v[52:53] op_sel_hi:[0,1]
    v_pk_mul_f32 v[62:63], v[58:59], v[54:55] op_sel_hi:[0,1]
    v_pk_fma_f32 v[60:61], v[56:57], v[52:53], v[60:61] op_sel:[1,1,0] op_sel_hi:[1,0,1] neg_lo:[1,0,0]
    v_pk_fma_f32 v[62:63], v[58:59], v[54:55], v[62:63] op_sel:[1,1,0] op_sel_hi:[1,0,1] neg_lo:[1,0,0]
    v_cvt_pk_bf16_f32 v44, v60, v61
    v_cvt_pk_bf16_f32 v45, v62, v63
    ds_write_b64 v20, v[44:45] offset:24064
    v_pk_mul_f32 v[56:57], v[60:61], v[52:53] op_sel_hi:[0,1]
    v_pk_mul_f32 v[58:59], v[62:63], v[54:55] op_sel_hi:[0,1]
    v_pk_fma_f32 v[56:57], v[60:61], v[52:53], v[56:57] op_sel:[1,1,0] op_sel_hi:[1,0,1] neg_lo:[1,0,0]
    v_pk_fma_f32 v[58:59], v[62:63], v[54:55], v[58:59] op_sel:[1,1,0] op_sel_hi:[1,0,1] neg_lo:[1,0,0]
    v_cvt_pk_bf16_f32 v46, v56, v57
    v_cvt_pk_bf16_f32 v47, v58, v59
    ds_write_b64 v20, v[46:47] offset:24592
    v_pk_mul_f32 v[60:61], v[56:57], v[52:53] op_sel_hi:[0,1]
    v_pk_mul_f32 v[62:63], v[58:59], v[54:55] op_sel_hi:[0,1]
    v_pk_fma_f32 v[60:61], v[56:57], v[52:53], v[60:61] op_sel:[1,1,0] op_sel_hi:[1,0,1] neg_lo:[1,0,0]
    v_pk_fma_f32 v[62:63], v[58:59], v[54:55], v[62:63] op_sel:[1,1,0] op_sel_hi:[1,0,1] neg_lo:[1,0,0]
    v_cvt_pk_bf16_f32 v48, v60, v61
    v_cvt_pk_bf16_f32 v49, v62, v63
    ds_write_b64 v20, v[48:49] offset:25120
    v_pk_mul_f32 v[56:57], v[60:61], v[52:53] op_sel_hi:[0,1]
    v_pk_mul_f32 v[58:59], v[62:63], v[54:55] op_sel_hi:[0,1]
    v_pk_fma_f32 v[56:57], v[60:61], v[52:53], v[56:57] op_sel:[1,1,0] op_sel_hi:[1,0,1] neg_lo:[1,0,0]
    v_pk_fma_f32 v[58:59], v[62:63], v[54:55], v[58:59] op_sel:[1,1,0] op_sel_hi:[1,0,1] neg_lo:[1,0,0]
    v_cvt_pk_bf16_f32 v44, v56, v57
    v_cvt_pk_bf16_f32 v45, v58, v59
    ds_write_b64 v20, v[44:45] offset:25648
    v_pk_mul_f32 v[60:61], v[56:57], v[52:53] op_sel_hi:[0,1]
    v_pk_mul_f32 v[62:63], v[58:59], v[54:55] op_sel_hi:[0,1]
    v_pk_fma_f32 v[60:61], v[56:57], v[52:53], v[60:61] op_sel:[1,1,0] op_sel_hi:[1,0,1] neg_lo:[1,0,0]
    v_pk_fma_f32 v[62:63], v[58:59], v[54:55], v[62:63] op_sel:[1,1,0] op_sel_hi:[1,0,1] neg_lo:[1,0,0]
    v_cvt_pk_bf16_f32 v46, v60, v61
    v_cvt_pk_bf16_f32 v47, v62, v63
    ds_write_b64 v20, v[46:47] offset:26176
    v_mov_b32 v30, s27
L_spin:
    ds_read_b32 v31, v30 offset:9000
    s_waitcnt lgkmcnt(0)
    v_cmp_ne_u32 vcc, 0, v31
    s_cbranch_vccz L_spin
    s_waitcnt vmcnt(0)
    ds_read_b128 v[48:51], v21 offset:26704
    ds_read_b128 v[52:55], v22 offset:9808
    ds_read_b128 v[56:59], v21 offset:26736
    ds_read_b128 v[60:63], v22 offset:9840
    ds_read_b128 v[64:67], v21 offset:26768
    ds_read_b128 v[68:71], v22 offset:9872
    ds_read_b128 v[72:75], v21 offset:26800
    ds_read_b128 v[76:79], v22 offset:9904
    s_waitcnt lgkmcnt(6)
    v_mfma_f32_32x32x16_bf16 v[32:47], v[48:51], v[52:55], 0
    ds_read_b128 v[48:51], v21 offset:26832
    ds_read_b128 v[52:55], v22 offset:9936
    s_waitcnt lgkmcnt(6)
    v_mfma_f32_32x32x16_bf16 v[32:47], v[56:59], v[60:63], v[32:47]
    ds_read_b128 v[56:59], v21 offset:26864
    ds_read_b128 v[60:63], v22 offset:9968
    s_waitcnt lgkmcnt(6)
    v_mfma_f32_32x32x16_bf16 v[32:47], v[64:67], v[68:71], v[32:47]
    ds_read_b128 v[64:67], v21 offset:26896
    ds_read_b128 v[68:71], v22 offset:10000
    s_waitcnt lgkmcnt(6)
    v_mfma_f32_32x32x16_bf16 v[32:47], v[72:75], v[76:79], v[32:47]
    ds_read_b128 v[72:75], v21 offset:26928
    ds_read_b128 v[76:79], v22 offset:10032
    s_waitcnt lgkmcnt(6)
    v_mfma_f32_32x32x16_bf16 v[32:47], v[48:51], v[52:55], v[32:47]
    ds_read_b128 v[48:51], v21 offset:26960
    ds_read_b128 v[52:55], v22 offset:10064
    s_waitcnt lgkmcnt(6)
    v_mfma_f32_32x32x16_bf16 v[32:47], v[56:59], v[60:63], v[32:47]
    ds_read_b128 v[56:59], v21 offset:26992
    ds_read_b128 v[60:63], v22 offset:10096
    s_waitcnt lgkmcnt(6)
    v_mfma_f32_32x32x16_bf16 v[32:47], v[64:67], v[68:71], v[32:47]
    ds_read_b128 v[64:67], v21 offset:27024
    ds_read_b128 v[68:71], v22 offset:10128
    s_waitcnt lgkmcnt(6)
    v_mfma_f32_32x32x16_bf16 v[32:47], v[72:75], v[76:79], v[32:47]
    ds_read_b128 v[72:75], v21 offset:27056
    ds_read_b128 v[76:79], v22 offset:10160
    s_waitcnt lgkmcnt(6)
    v_mfma_f32_32x32x16_bf16 v[32:47], v[48:51], v[52:55], v[32:47]
    ds_read_b128 v[48:51], v21 offset:27088
    ds_read_b128 v[52:55], v22 offset:10192
    s_waitcnt lgkmcnt(6)
    v_mfma_f32_32x32x16_bf16 v[32:47], v[56:59], v[60:63], v[32:47]
    ds_read_b128 v[56:59], v21 offset:27120
    ds_read_b128 v[60:63], v22 offset:10224
    s_waitcnt lgkmcnt(6)
    v_mfma_f32_32x32x16_bf16 v[32:47], v[64:67], v[68:71], v[32:47]
    ds_read_b128 v[64:67], v21 offset:27152
    ds_read_b128 v[68:71], v22 offset:10256
    s_waitcnt lgkmcnt(6)
    v_mfma_f32_32x32x16_bf16 v[32:47], v[72:75], v[76:79], v[32:47]
    ds_read_b128 v[72:75], v21 offset:27184
    ds_read_b128 v[76:79], v22 offset:10288
    s_waitcnt lgkmcnt(6)
    v_mfma_f32_32x32x16_bf16 v[32:47], v[48:51], v[52:55], v[32:47]
    s_waitcnt lgkmcnt(4)
    v_mfma_f32_32x32x16_bf16 v[32:47], v[56:59], v[60:63], v[32:47]
    s_waitcnt lgkmcnt(2)
    v_mfma_f32_32x32x16_bf16 v[32:47], v[64:67], v[68:71], v[32:47]
    s_waitcnt lgkmcnt(0)
    v_mfma_f32_32x32x16_bf16 v[32:47], v[72:75], v[76:79], v[32:47]
    s_nop 7
    s_nop 7
    s_nop 2
    v_add_f32 v32, v32, v29
    v_cndmask_b32 v64, v43, v44, s[40:41]
    v_cndmask_b32 v65, v45, v46, s[40:41]
    v_cvt_pk_bf16_f32 v60, v46, v46
    v_cvt_pk_bf16_f32 v61, v46, v65
    v_cvt_pk_bf16_f32 v62, v45, v45
    v_cvt_pk_bf16_f32 v63, v45, v45
    ds_write_b128 v23, v[60:63] offset:12880
    v_cvt_pk_bf16_f32 v56, v44, v44
    v_cvt_pk_bf16_f32 v57, v44, v64
    v_cvt_pk_bf16_f32 v58, v43, v43
    v_cvt_pk_bf16_f32 v59, v43, v43
    ds_write_b128 v23, v[56:59] offset:11856
    s_cmp_lg_u32 s7, 0
    s_cbranch_scc1 L_convA
L_convB:
    s_setprio 1
    ds_read_b128 v[96:99], v27 offset:12336
    ds_read_b128 v[100:103], v27 offset:12848
    ds_read_b128 v[104:107], v27 offset:13360
    ds_read_b128 v[108:111], v27 offset:12272
    ds_read_b128 v[112:115], v27 offset:12784
    ds_read_b128 v[116:119], v27 offset:13296
    ds_read_b128 v[120:123], v27 offset:12208
    ds_read_b128 v[124:127], v27 offset:12720
    ds_read_b128 v[128:131], v27 offset:13232
    v_cvt_pk_bf16_f32 v52, v42, v42
    v_cvt_pk_bf16_f32 v53, v41, v41
    v_cvt_pk_bf16_f32 v54, v41, v40
    v_cvt_pk_bf16_f32 v55, v40, v40
    ds_write_b128 v23, v[52:55] offset:10832
    v_cvt_pk_bf16_f32 v48, v39, v38
    v_cvt_pk_bf16_f32 v49, v37, v36
    v_cvt_pk_bf16_f32 v50, v35, v34
    v_cvt_pk_bf16_f32 v51, v33, v32
    ds_write_b128 v23, v[48:51] offset:9808
    s_barrier
    ds_read_b64 v[80:81], v24 offset:0
    ds_read_b64 v[82:83], v24 offset:8
    ds_read_b64 v[84:85], v24 offset:64
    ds_read_b64 v[86:87], v24 offset:72
    ds_read_b64 v[88:89], v24 offset:128
    ds_read_b64 v[90:91], v24 offset:136
    ds_read_b64 v[92:93], v24 offset:192
    ds_read_b64 v[94:95], v24 offset:200
    s_waitcnt lgkmcnt(6)
    v_mfma_f32_16x16x32_bf16 v[32:35], v[80:83], v[96:99], 0
    ds_read_b128 v[132:135], v27 offset:12144
    ds_read_b128 v[136:139], v27 offset:12656
    v_mfma_f32_16x16x32_bf16 v[36:39], v[80:83], v[100:103], 0
    ds_read_b128 v[140:143], v27 offset:13168
    ds_read_b64 v[144:145], v24 offset:256
    v_mfma_f32_16x16x32_bf16 v[40:43], v[80:83], v[104:107], 0
    ds_read_b64 v[146:147], v24 offset:264
    s_waitcnt lgkmcnt(9)
    v_mfma_f32_16x16x32_bf16 v[32:35], v[84:87], v[108:111], v[32:35]
    ds_read_b128 v[148:151], v27 offset:12080
    ds_read_b128 v[152:155], v27 offset:12592
    v_mfma_f32_16x16x32_bf16 v[36:39], v[84:87], v[112:115], v[36:39]
    ds_read_b128 v[156:159], v27 offset:13104
    ds_read_b64 v[160:161], v24 offset:320
    v_mfma_f32_16x16x32_bf16 v[40:43], v[84:87], v[116:119], v[40:43]
    ds_read_b64 v[162:163], v24 offset:328
    s_waitcnt lgkmcnt(8)
    v_mfma_f32_16x16x32_bf16 v[32:35], v[88:91], v[120:123], v[32:35]
    ds_read_b128 v[164:167], v27 offset:12016
    ds_read_b128 v[64:67], v27 offset:12528
    v_mfma_f32_16x16x32_bf16 v[36:39], v[88:91], v[124:127], v[36:39]
    ds_read_b128 v[68:71], v27 offset:13040
    ds_read_b64 v[72:73], v24 offset:384
    v_mfma_f32_16x16x32_bf16 v[40:43], v[88:91], v[128:131], v[40:43]
    ds_read_b64 v[74:75], v24 offset:392
    s_waitcnt lgkmcnt(8)
    v_mfma_f32_16x16x32_bf16 v[32:35], v[92:95], v[132:135], v[32:35]
    ds_read_b128 v[76:79], v27 offset:11952
    ds_read_b128 v[4:7], v27 offset:12464
    v_mfma_f32_16x16x32_bf16 v[36:39], v[92:95], v[136:139], v[36:39]
    ds_read_b128 v[8:11], v27 offset:12976
    ds_read_b64 v[12:13], v24 offset:448
    v_mfma_f32_16x16x32_bf16 v[40:43], v[92:95], v[140:143], v[40:43]
    ds_read_b64 v[14:15], v24 offset:456
    s_waitcnt lgkmcnt(8)
    v_mfma_f32_16x16x32_bf16 v[32:35], v[144:147], v[148:151], v[32:35]
    ds_read_b128 v[16:19], v27 offset:11888
    ds_read_b128 v[44:47], v27 offset:12400
    v_mfma_f32_16x16x32_bf16 v[36:39], v[144:147], v[152:155], v[36:39]
    ds_read_b128 v[48:51], v27 offset:12912
    ds_read_b64 v[52:53], v24 offset:512
    v_mfma_f32_16x16x32_bf16 v[40:43], v[144:147], v[156:159], v[40:43]
    ds_read_b64 v[54:55], v24 offset:520
    s_waitcnt lgkmcnt(8)
    v_mfma_f32_16x16x32_bf16 v[32:35], v[160:163], v[164:167], v[32:35]
    ds_read_b128 v[56:59], v27 offset:11824
    ds_read_b64 v[60:61], v24 offset:576
    v_mfma_f32_16x16x32_bf16 v[36:39], v[160:163], v[64:67], v[36:39]
    ds_read_b64 v[62:63], v24 offset:584
    v_mfma_f32_16x16x32_bf16 v[40:43], v[160:163], v[68:71], v[40:43]
    ds_read_b128 v[80:83], v27 offset:11760
    s_waitcnt lgkmcnt(8)
    v_mfma_f32_16x16x32_bf16 v[32:35], v[72:75], v[76:79], v[32:35]
    ds_read_b64 v[104:105], v24 offset:640
    v_mfma_f32_16x16x32_bf16 v[36:39], v[72:75], v[4:7], v[36:39]
    ds_read_b64 v[106:107], v24 offset:648
    v_mfma_f32_16x16x32_bf16 v[40:43], v[72:75], v[8:11], v[40:43]
    ds_read_b128 v[84:87], v27 offset:11696
    s_waitcnt lgkmcnt(9)
    v_mfma_f32_16x16x32_bf16 v[32:35], v[12:15], v[16:19], v[32:35]
    ds_read_b64 v[116:117], v24 offset:704
    v_mfma_f32_16x16x32_bf16 v[36:39], v[12:15], v[44:47], v[36:39]
    ds_read_b64 v[118:119], v24 offset:712
    v_mfma_f32_16x16x32_bf16 v[40:43], v[12:15], v[48:51], v[40:43]
    ds_read_b128 v[88:91], v27 offset:11632
    s_waitcnt lgkmcnt(8)
    v_mfma_f32_16x16x32_bf16 v[32:35], v[52:55], v[56:59], v[32:35]
    ds_read_b64 v[128:129], v24 offset:768
    v_mfma_f32_16x16x32_bf16 v[36:39], v[52:55], v[96:99], v[36:39]
    ds_read_b64 v[130:131], v24 offset:776
    v_mfma_f32_16x16x32_bf16 v[40:43], v[52:55], v[100:103], v[40:43]
    ds_read_b128 v[92:95], v27 offset:11568
    s_waitcnt lgkmcnt(9)
    v_mfma_f32_16x16x32_bf16 v[32:35], v[60:63], v[80:83], v[32:35]
    ds_read_b64 v[140:141], v24 offset:832
    v_mfma_f32_16x16x32_bf16 v[36:39], v[60:63], v[108:111], v[36:39]
    ds_read_b64 v[142:143], v24 offset:840
    v_mfma_f32_16x16x32_bf16 v[40:43], v[60:63], v[112:115], v[40:43]
    ds_read_b128 v[144:147], v27 offset:11504
    s_waitcnt lgkmcnt(8)
    v_mfma_f32_16x16x32_bf16 v[32:35], v[104:107], v[84:87], v[32:35]
    ds_read_b64 v[156:157], v24 offset:896
    v_mfma_f32_16x16x32_bf16 v[36:39], v[104:107], v[120:123], v[36:39]
    ds_read_b64 v[158:159], v24 offset:904
    v_mfma_f32_16x16x32_bf16 v[40:43], v[104:107], v[124:127], v[40:43]
    ds_read_b128 v[160:163], v27 offset:11440
    s_waitcnt lgkmcnt(9)
    v_mfma_f32_16x16x32_bf16 v[32:35], v[116:119], v[88:91], v[32:35]
    ds_read_b64 v[68:69], v24 offset:960
    v_mfma_f32_16x16x32_bf16 v[36:39], v[116:119], v[132:135], v[36:39]
    ds_read_b64 v[70:71], v24 offset:968
    v_mfma_f32_16x16x32_bf16 v[40:43], v[116:119], v[136:139], v[40:43]
    ds_read_b128 v[72:75], v27 offset:11376
    s_waitcnt lgkmcnt(8)
    v_mfma_f32_16x16x32_bf16 v[32:35], v[128:131], v[92:95], v[32:35]
    ds_read_b64 v[8:9], v24 offset:1024
    v_mfma_f32_16x16x32_bf16 v[36:39], v[128:131], v[148:151], v[36:39]
    ds_read_b64 v[10:11], v24 offset:1032
    v_mfma_f32_16x16x32_bf16 v[40:43], v[128:131], v[152:155], v[40:43]
    ds_read_b128 v[12:15], v27 offset:11312
    s_waitcnt lgkmcnt(9)
    v_mfma_f32_16x16x32_bf16 v[32:35], v[140:143], v[144:147], v[32:35]
    ds_read_b64 v[48:49], v24 offset:1088
    v_mfma_f32_16x16x32_bf16 v[36:39], v[140:143], v[164:167], v[36:39]
    ds_read_b64 v[50:51], v24 offset:1096
    v_mfma_f32_16x16x32_bf16 v[40:43], v[140:143], v[64:67], v[40:43]
    ds_read_b128 v[52:55], v27 offset:11248
    s_waitcnt lgkmcnt(8)
    v_mfma_f32_16x16x32_bf16 v[32:35], v[156:159], v[160:163], v[32:35]
    ds_read_b64 v[100:101], v24 offset:1152
    v_mfma_f32_16x16x32_bf16 v[36:39], v[156:159], v[76:79], v[36:39]
    ds_read_b64 v[102:103], v24 offset:1160
    v_mfma_f32_16x16x32_bf16 v[40:43], v[156:159], v[4:7], v[40:43]
    ds_read_b128 v[60:63], v27 offset:11184
    s_waitcnt lgkmcnt(9)
    v_mfma_f32_16x16x32_bf16 v[32:35], v[68:71], v[72:75], v[32:35]
    ds_read_b64 v[112:113], v24 offset:1216
    v_mfma_f32_16x16x32_bf16 v[36:39], v[68:71], v[16:19], v[36:39]
    ds_read_b64 v[114:115], v24 offset:1224
    v_mfma_f32_16x16x32_bf16 v[40:43], v[68:71], v[44:47], v[40:43]
    ds_read_b128 v[104:107], v27 offset:11120
    s_waitcnt lgkmcnt(8)
    v_mfma_f32_16x16x32_bf16 v[32:35], v[8:11], v[12:15], v[32:35]
    ds_read_b64 v[124:125], v24 offset:1280
    v_mfma_f32_16x16x32_bf16 v[36:39], v[8:11], v[56:59], v[36:39]
    ds_read_b64 v[126:127], v24 offset:1288
    v_mfma_f32_16x16x32_bf16 v[40:43], v[8:11], v[96:99], v[40:43]
    ds_read_b128 v[116:119], v27 offset:11056
    s_waitcnt lgkmcnt(9)
    v_mfma_f32_16x16x32_bf16 v[32:35], v[48:51], v[52:55], v[32:35]
    ds_read_b64 v[136:137], v24 offset:1344
    v_mfma_f32_16x16x32_bf16 v[36:39], v[48:51], v[80:83], v[36:39]
    ds_read_b64 v[138:139], v24 offset:1352
    v_mfma_f32_16x16x32_bf16 v[40:43], v[48:51], v[108:111], v[40:43]
    ds_read_b128 v[128:131], v27 offset:10992
    s_waitcnt lgkmcnt(8)
    v_mfma_f32_16x16x32_bf16 v[32:35], v[100:103], v[60:63], v[32:35]
    ds_read_b64 v[152:153], v24 offset:1408
    v_mfma_f32_16x16x32_bf16 v[36:39], v[100:103], v[84:87], v[36:39]
    ds_read_b64 v[154:155], v24 offset:1416
    v_mfma_f32_16x16x32_bf16 v[40:43], v[100:103], v[120:123], v[40:43]
    ds_read_b128 v[140:143], v27 offset:10928
    s_waitcnt lgkmcnt(9)
    v_mfma_f32_16x16x32_bf16 v[32:35], v[112:115], v[104:107], v[32:35]
    ds_read_b64 v[64:65], v24 offset:1472
    v_mfma_f32_16x16x32_bf16 v[36:39], v[112:115], v[88:91], v[36:39]
    ds_read_b64 v[66:67], v24 offset:1480
    v_mfma_f32_16x16x32_bf16 v[40:43], v[112:115], v[132:135], v[40:43]
    ds_read_b128 v[156:159], v27 offset:10864
    s_waitcnt lgkmcnt(8)
    v_mfma_f32_16x16x32_bf16 v[32:35], v[124:127], v[116:119], v[32:35]
    ds_read_b64 v[4:5], v24 offset:1536
    v_mfma_f32_16x16x32_bf16 v[36:39], v[124:127], v[92:95], v[36:39]
    ds_read_b64 v[6:7], v24 offset:1544
    v_mfma_f32_16x16x32_bf16 v[40:43], v[124:127], v[148:151], v[40:43]
    ds_read_b128 v[68:71], v27 offset:10800
    s_waitcnt lgkmcnt(9)
    v_mfma_f32_16x16x32_bf16 v[32:35], v[136:139], v[128:131], v[32:35]
    ds_read_b64 v[44:45], v24 offset:1600
    v_mfma_f32_16x16x32_bf16 v[36:39], v[136:139], v[144:147], v[36:39]
    ds_read_b64 v[46:47], v24 offset:1608
    v_mfma_f32_16x16x32_bf16 v[40:43], v[136:139], v[164:167], v[40:43]
    ds_read_b128 v[8:11], v27 offset:10736
    s_waitcnt lgkmcnt(8)
    v_mfma_f32_16x16x32_bf16 v[32:35], v[152:155], v[140:143], v[32:35]
    ds_read_b64 v[96:97], v24 offset:1664
    v_mfma_f32_16x16x32_bf16 v[36:39], v[152:155], v[160:163], v[36:39]
    ds_read_b64 v[98:99], v24 offset:1672
    v_mfma_f32_16x16x32_bf16 v[40:43], v[152:155], v[76:79], v[40:43]
    ds_read_b128 v[48:51], v27 offset:10672
    s_waitcnt lgkmcnt(9)
    v_mfma_f32_16x16x32_bf16 v[32:35], v[64:67], v[156:159], v[32:35]
    ds_read_b64 v[108:109], v24 offset:1728
    v_mfma_f32_16x16x32_bf16 v[36:39], v[64:67], v[72:75], v[36:39]
    ds_read_b64 v[110:111], v24 offset:1736
    v_mfma_f32_16x16x32_bf16 v[40:43], v[64:67], v[16:19], v[40:43]
    ds_read_b128 v[100:103], v27 offset:10608
    s_waitcnt lgkmcnt(8)
    v_mfma_f32_16x16x32_bf16 v[32:35], v[4:7], v[68:71], v[32:35]
    ds_read_b64 v[120:121], v24 offset:1792
    v_mfma_f32_16x16x32_bf16 v[36:39], v[4:7], v[12:15], v[36:39]
    ds_read_b64 v[122:123], v24 offset:1800
    v_mfma_f32_16x16x32_bf16 v[40:43], v[4:7], v[56:59], v[40:43]
    ds_read_b128 v[112:115], v27 offset:10544
    s_waitcnt lgkmcnt(9)
    v_mfma_f32_16x16x32_bf16 v[32:35], v[44:47], v[8:11], v[32:35]
    ds_read_b64 v[132:133], v24 offset:1856
    v_mfma_f32_16x16x32_bf16 v[36:39], v[44:47], v[52:55], v[36:39]
    ds_read_b64 v[134:135], v24 offset:1864
    v_mfma_f32_16x16x32_bf16 v[40:43], v[44:47], v[80:83], v[40:43]
    ds_read_b128 v[124:127], v27 offset:10480
    s_waitcnt lgkmcnt(8)
    v_mfma_f32_16x16x32_bf16 v[32:35], v[96:99], v[48:51], v[32:35]
    ds_read_b64 v[148:149], v24 offset:1920
    v_mfma_f32_16x16x32_bf16 v[36:39], v[96:99], v[60:63], v[36:39]
    ds_read_b64 v[150:151], v24 offset:1928
    v_mfma_f32_16x16x32_bf16 v[40:43], v[96:99], v[84:87], v[40:43]
    ds_read_b128 v[136:139], v27 offset:10416
    s_waitcnt lgkmcnt(9)
    v_mfma_f32_16x16x32_bf16 v[32:35], v[108:111], v[100:103], v[32:35]
    ds_read_b64 v[164:165], v24 offset:1984
    v_mfma_f32_16x16x32_bf16 v[36:39], v[108:111], v[104:107], v[36:39]
    ds_read_b64 v[166:167], v24 offset:1992
    v_mfma_f32_16x16x32_bf16 v[40:43], v[108:111], v[88:91], v[40:43]
    ds_read_b128 v[152:155], v27 offset:10352
    s_waitcnt lgkmcnt(8)
    v_mfma_f32_16x16x32_bf16 v[32:35], v[120:123], v[112:115], v[32:35]
    s_barrier
    v_mfma_f32_16x16x32_bf16 v[36:39], v[120:123], v[116:119], v[36:39]
    ds_read_b64 v[76:77], v25 offset:2048
    v_mfma_f32_16x16x32_bf16 v[40:43], v[120:123], v[92:95], v[40:43]
    ds_read_b64 v[78:79], v26 offset:2056
    s_waitcnt lgkmcnt(8)
    v_mfma_f32_16x16x32_bf16 v[32:35], v[132:135], v[124:127], v[32:35]
    ds_read_b128 v[64:67], v27 offset:10288
    ds_read_b64 v[16:17], v24 offset:13992
    v_mfma_f32_16x16x32_bf16 v[36:39], v[132:135], v[128:131], v[36:39]
    ds_read_b64 v[18:19], v24 offset:14000
    v_mfma_f32_16x16x32_bf16 v[40:43], v[132:135], v[144:147], v[40:43]
    ds_read_b128 v[4:7], v27 offset:10224
    s_waitcnt lgkmcnt(8)
    v_mfma_f32_16x16x32_bf16 v[32:35], v[148:151], v[136:139], v[32:35]
    ds_read_b64 v[56:57], v24 offset:14056
    v_mfma_f32_16x16x32_bf16 v[36:39], v[148:151], v[140:143], v[36:39]
    ds_read_b64 v[58:59], v24 offset:14064
    v_mfma_f32_16x16x32_bf16 v[40:43], v[148:151], v[160:163], v[40:43]
    ds_read_b128 v[44:47], v27 offset:10160
    s_waitcnt lgkmcnt(9)
    v_mfma_f32_16x16x32_bf16 v[32:35], v[164:167], v[152:155], v[32:35]
    ds_read_b64 v[80:81], v24 offset:14120
    v_mfma_f32_16x16x32_bf16 v[36:39], v[164:167], v[156:159], v[36:39]
    ds_read_b64 v[82:83], v24 offset:14128
    v_mfma_f32_16x16x32_bf16 v[40:43], v[164:167], v[72:75], v[40:43]
    ds_read_b128 v[96:99], v27 offset:10096
    s_waitcnt lgkmcnt(8)
    v_mfma_f32_16x16x32_bf16 v[32:35], v[76:79], v[64:67], v[32:35]
    ds_read_b64 v[84:85], v24 offset:14184
    v_mfma_f32_16x16x32_bf16 v[36:39], v[76:79], v[68:71], v[36:39]
    ds_read_b64 v[86:87], v24 offset:14192
    v_mfma_f32_16x16x32_bf16 v[40:43], v[76:79], v[12:15], v[40:43]
    ds_read_b128 v[108:111], v27 offset:10032
    s_waitcnt lgkmcnt(9)
    v_mfma_f32_16x16x32_bf16 v[32:35], v[16:19], v[4:7], v[32:35]
    ds_read_b64 v[88:89], v24 offset:14248
    v_mfma_f32_16x16x32_bf16 v[36:39], v[16:19], v[8:11], v[36:39]
    ds_read_b64 v[90:91], v24 offset:14256
    v_mfma_f32_16x16x32_bf16 v[40:43], v[16:19], v[52:55], v[40:43]
    ds_read_b128 v[120:123], v27 offset:9968
    s_waitcnt lgkmcnt(8)
    v_mfma_f32_16x16x32_bf16 v[32:35], v[56:59], v[44:47], v[32:35]
    ds_read_b64 v[92:93], v24 offset:14312
    v_mfma_f32_16x16x32_bf16 v[36:39], v[56:59], v[48:51], v[36:39]
    ds_read_b64 v[94:95], v24 offset:14320
    v_mfma_f32_16x16x32_bf16 v[40:43], v[56:59], v[60:63], v[40:43]
    ds_read_b128 v[132:135], v27 offset:9904
    s_waitcnt lgkmcnt(9)
    v_mfma_f32_16x16x32_bf16 v[32:35], v[80:83], v[96:99], v[32:35]
    ds_read_b64 v[144:145], v24 offset:14376
    v_mfma_f32_16x16x32_bf16 v[36:39], v[80:83], v[100:103], v[36:39]
    ds_read_b64 v[146:147], v24 offset:14384
    v_mfma_f32_16x16x32_bf16 v[40:43], v[80:83], v[104:107], v[40:43]
    ds_read_b128 v[148:151], v27 offset:9840
    s_waitcnt lgkmcnt(8)
    v_mfma_f32_16x16x32_bf16 v[32:35], v[84:87], v[108:111], v[32:35]
    ds_read_b64 v[160:161], v24 offset:14440
    v_mfma_f32_16x16x32_bf16 v[36:39], v[84:87], v[112:115], v[36:39]
    ds_read_b64 v[162:163], v24 offset:14448
    v_mfma_f32_16x16x32_bf16 v[40:43], v[84:87], v[116:119], v[40:43]
    ds_read_b128 v[164:167], v27 offset:9776
    s_waitcnt lgkmcnt(9)
    v_mfma_f32_16x16x32_bf16 v[32:35], v[88:91], v[120:123], v[32:35]
    ds_read_b64 v[72:73], v24 offset:14504
    v_mfma_f32_16x16x32_bf16 v[36:39], v[88:91], v[124:127], v[36:39]
    ds_read_b64 v[74:75], v24 offset:14512
    v_mfma_f32_16x16x32_bf16 v[40:43], v[88:91], v[128:131], v[40:43]
    ds_read_b128 v[76:79], v27 offset:9712
    s_waitcnt lgkmcnt(8)
    v_mfma_f32_16x16x32_bf16 v[32:35], v[92:95], v[132:135], v[32:35]
    ds_read_b64 v[12:13], v24 offset:14568
    v_mfma_f32_16x16x32_bf16 v[36:39], v[92:95], v[136:139], v[36:39]
    ds_read_b64 v[14:15], v24 offset:14576
    v_mfma_f32_16x16x32_bf16 v[40:43], v[92:95], v[140:143], v[40:43]
    ds_read_b128 v[16:19], v27 offset:9648
    s_waitcnt lgkmcnt(9)
    v_mfma_f32_16x16x32_bf16 v[32:35], v[144:147], v[148:151], v[32:35]
    ds_read_b64 v[52:53], v24 offset:14632
    v_mfma_f32_16x16x32_bf16 v[36:39], v[144:147], v[152:155], v[36:39]
    ds_read_b64 v[54:55], v24 offset:14640
    v_mfma_f32_16x16x32_bf16 v[40:43], v[144:147], v[156:159], v[40:43]
    ds_read_b128 v[56:59], v27 offset:9584
    s_waitcnt lgkmcnt(8)
    v_mfma_f32_16x16x32_bf16 v[32:35], v[160:163], v[164:167], v[32:35]
    ds_read_b64 v[60:61], v24 offset:14696
    v_mfma_f32_16x16x32_bf16 v[36:39], v[160:163], v[64:67], v[36:39]
    ds_read_b64 v[62:63], v24 offset:14704
    v_mfma_f32_16x16x32_bf16 v[40:43], v[160:163], v[68:71], v[40:43]
    ds_read_b128 v[80:83], v27 offset:9520
    s_waitcnt lgkmcnt(9)
    v_mfma_f32_16x16x32_bf16 v[32:35], v[72:75], v[76:79], v[32:35]
    ds_read_b64 v[104:105], v24 offset:14760
    v_mfma_f32_16x16x32_bf16 v[36:39], v[72:75], v[4:7], v[36:39]
    ds_read_b64 v[106:107], v24 offset:14768
    v_mfma_f32_16x16x32_bf16 v[40:43], v[72:75], v[8:11], v[40:43]
    ds_read_b128 v[84:87], v27 offset:9456
    s_waitcnt lgkmcnt(8)
    v_mfma_f32_16x16x32_bf16 v[32:35], v[12:15], v[16:19], v[32:35]
    ds_read_b64 v[116:117], v24 offset:14824
    v_mfma_f32_16x16x32_bf16 v[36:39], v[12:15], v[44:47], v[36:39]
    ds_read_b64 v[118:119], v24 offset:14832
    v_mfma_f32_16x16x32_bf16 v[40:43], v[12:15], v[48:51], v[40:43]
    ds_read_b128 v[88:91], v27 offset:9392
    s_waitcnt lgkmcnt(9)
    v_mfma_f32_16x16x32_bf16 v[32:35], v[52:55], v[56:59], v[32:35]
    ds_read_b64 v[128:129], v24 offset:14888
    v_mfma_f32_16x16x32_bf16 v[36:39], v[52:55], v[96:99], v[36:39]
    ds_read_b64 v[130:131], v24 offset:14896
    v_mfma_f32_16x16x32_bf16 v[40:43], v[52:55], v[100:103], v[40:43]
    ds_read_b128 v[92:95], v27 offset:9328
    s_waitcnt lgkmcnt(8)
    v_mfma_f32_16x16x32_bf16 v[32:35], v[60:63], v[80:83], v[32:35]
    ds_read_b64 v[140:141], v24 offset:14952
    v_mfma_f32_16x16x32_bf16 v[36:39], v[60:63], v[108:111], v[36:39]
    ds_read_b64 v[142:143], v24 offset:14960
    v_mfma_f32_16x16x32_bf16 v[40:43], v[60:63], v[112:115], v[40:43]
    ds_read_b64 v[144:145], v24 offset:15016
    s_waitcnt lgkmcnt(9)
    v_mfma_f32_16x16x32_bf16 v[32:35], v[104:107], v[84:87], v[32:35]
    ds_read_b64 v[146:147], v24 offset:15024
    v_mfma_f32_16x16x32_bf16 v[36:39], v[104:107], v[120:123], v[36:39]
    ds_read_b64 v[156:157], v24 offset:15080
    v_mfma_f32_16x16x32_bf16 v[40:43], v[104:107], v[124:127], v[40:43]
    ds_read_b64 v[158:159], v24 offset:15088
    s_waitcnt lgkmcnt(8)
    v_mfma_f32_16x16x32_bf16 v[32:35], v[116:119], v[88:91], v[32:35]
    ds_read_b64 v[160:161], v24 offset:15144
    v_mfma_f32_16x16x32_bf16 v[36:39], v[116:119], v[132:135], v[36:39]
    ds_read_b64 v[162:163], v24 offset:15152
    v_mfma_f32_16x16x32_bf16 v[40:43], v[116:119], v[136:139], v[40:43]
    ds_read_b64 v[68:69], v24 offset:15208
    s_waitcnt lgkmcnt(9)
    v_mfma_f32_16x16x32_bf16 v[32:35], v[128:131], v[92:95], v[32:35]
    ds_read_b64 v[70:71], v24 offset:15216
    v_mfma_f32_16x16x32_bf16 v[36:39], v[128:131], v[148:151], v[36:39]
    ds_read_b64 v[72:73], v24 offset:15272
    v_mfma_f32_16x16x32_bf16 v[40:43], v[128:131], v[152:155], v[40:43]
    ds_read_b64 v[74:75], v24 offset:15280
    s_waitcnt lgkmcnt(8)
    v_mfma_f32_16x16x32_bf16 v[36:39], v[140:143], v[164:167], v[36:39]
    ds_read_b64 v[8:9], v24 offset:15336
    v_mfma_f32_16x16x32_bf16 v[40:43], v[140:143], v[64:67], v[40:43]
    v_cvt_pk_bf16_f32 v32, v32, v33
    v_cvt_pk_bf16_f32 v33, v34, v35
    ds_write_b64 v28, v[32:33] offset:22400
    v_mfma_f32_16x16x32_bf16 v[36:39], v[144:147], v[76:79], v[36:39]
    ds_read_b64 v[10:11], v24 offset:15344
    v_mfma_f32_16x16x32_bf16 v[40:43], v[144:147], v[4:7], v[40:43]
    ds_read_b64 v[12:13], v24 offset:15400
    s_waitcnt lgkmcnt(8)
    v_mfma_f32_16x16x32_bf16 v[36:39], v[156:159], v[16:19], v[36:39]
    ds_read_b64 v[14:15], v24 offset:15408
    v_mfma_f32_16x16x32_bf16 v[40:43], v[156:159], v[44:47], v[40:43]
    ds_read_b64 v[48:49], v24 offset:15464
    v_mfma_f32_16x16x32_bf16 v[36:39], v[160:163], v[56:59], v[36:39]
    ds_read_b64 v[50:51], v24 offset:15472
    v_mfma_f32_16x16x32_bf16 v[40:43], v[160:163], v[96:99], v[40:43]
    ds_read_b64 v[52:53], v24 offset:15528
    s_waitcnt lgkmcnt(8)
    v_mfma_f32_16x16x32_bf16 v[36:39], v[68:71], v[80:83], v[36:39]
    ds_read_b64 v[54:55], v24 offset:15536
    ds_read_b64 v[100:101], v24 offset:15592
    v_mfma_f32_16x16x32_bf16 v[40:43], v[68:71], v[108:111], v[40:43]
    ds_read_b64 v[102:103], v24 offset:15600
    ds_read_b64 v[60:61], v24 offset:15656
    s_waitcnt lgkmcnt(8)
    v_mfma_f32_16x16x32_bf16 v[36:39], v[72:75], v[84:87], v[36:39]
    s_barrier
    ds_read_b64 v[62:63], v24 offset:15664
    v_mfma_f32_16x16x32_bf16 v[40:43], v[72:75], v[120:123], v[40:43]
    ds_read_b64 v[112:113], v24 offset:15720
    ds_read_b64 v[114:115], v24 offset:15728
    v_mfma_f32_16x16x32_bf16 v[36:39], v[8:11], v[88:91], v[36:39]
    ds_read_b64 v[104:105], v24 offset:15784
    ds_read_b64 v[106:107], v24 offset:15792
    v_mfma_f32_16x16x32_bf16 v[40:43], v[8:11], v[132:135], v[40:43]
    ds_read_b64 v[124:125], v24 offset:15848
    s_waitcnt lgkmcnt(8)
    v_mfma_f32_16x16x32_bf16 v[36:39], v[12:15], v[92:95], v[36:39]
    ds_read_b64 v[126:127], v24 offset:15856
    ds_read_b64 v[116:117], v24 offset:15912
    v_mfma_f32_16x16x32_bf16 v[40:43], v[12:15], v[148:151], v[40:43]
    ds_read_b64 v[118:119], v24 offset:15920
    v_mfma_f32_16x16x32_bf16 v[40:43], v[48:51], v[164:167], v[40:43]
    v_mfma_f32_16x16x32_bf16 v[40:43], v[52:55], v[76:79], v[40:43]
    s_waitcnt lgkmcnt(10)
    v_mfma_f32_16x16x32_bf16 v[40:43], v[100:103], v[16:19], v[40:43]
    v_cvt_pk_bf16_f32 v36, v36, v37
    v_cvt_pk_bf16_f32 v37, v38, v39
    ds_write_b64 v28, v[36:37] offset:22976
    s_waitcnt lgkmcnt(9)
    v_mfma_f32_16x16x32_bf16 v[40:43], v[60:63], v[56:59], v[40:43]
    s_waitcnt lgkmcnt(7)
    v_mfma_f32_16x16x32_bf16 v[40:43], v[112:115], v[80:83], v[40:43]
    s_waitcnt lgkmcnt(5)
    v_mfma_f32_16x16x32_bf16 v[40:43], v[104:107], v[84:87], v[40:43]
    s_waitcnt lgkmcnt(3)
    v_mfma_f32_16x16x32_bf16 v[40:43], v[124:127], v[88:91], v[40:43]
    s_waitcnt lgkmcnt(1)
    v_mfma_f32_16x16x32_bf16 v[40:43], v[116:119], v[92:95], v[40:43]
    s_waitcnt lgkmcnt(0)
    s_barrier
    s_nop 5
    v_cvt_pk_bf16_f32 v40, v40, v41
    v_cvt_pk_bf16_f32 v41, v42, v43
    ds_write_b64 v28, v[40:41] offset:23552
    s_waitcnt lgkmcnt(0)
    s_barrier
L_fin:
    s_endpgm
L_convA:
    s_setprio 1
    v_cvt_pk_bf16_f32 v52, v42, v42
    v_cvt_pk_bf16_f32 v53, v41, v41
    v_cvt_pk_bf16_f32 v54, v41, v40
    v_cvt_pk_bf16_f32 v55, v40, v40
    ds_write_b128 v23, v[52:55] offset:10832
    v_cvt_pk_bf16_f32 v48, v39, v38
    v_cvt_pk_bf16_f32 v49, v37, v36
    v_cvt_pk_bf16_f32 v50, v35, v34
    v_cvt_pk_bf16_f32 v51, v33, v32
    ds_write_b128 v23, v[48:51] offset:9808
    ds_read_b128 v[96:99], v27 offset:9776
    ds_read_b128 v[100:103], v27 offset:10288
    ds_read_b128 v[104:107], v27 offset:10800
    ds_read_b128 v[108:111], v27 offset:11312
    ds_read_b128 v[112:115], v27 offset:11824
    ds_read_b128 v[116:119], v27 offset:9712
    ds_read_b128 v[120:123], v27 offset:10224
    ds_read_b128 v[124:127], v27 offset:10736
    ds_read_b128 v[128:131], v27 offset:11248
    s_barrier
    ds_read_b64 v[80:81], v24 offset:0
    ds_read_b64 v[82:83], v24 offset:8
    ds_read_b64 v[84:85], v24 offset:64
    ds_read_b64 v[86:87], v24 offset:72
    ds_read_b64 v[88:89], v24 offset:128
    ds_read_b64 v[90:91], v24 offset:136
    ds_read_b64 v[92:93], v24 offset:192
    ds_read_b64 v[94:95], v24 offset:200
    s_waitcnt lgkmcnt(6)
    v_mfma_f32_16x16x32_bf16 v[32:35], v[80:83], v[96:99], 0
    ds_read_b128 v[132:135], v27 offset:11760
    ds_read_b128 v[136:139], v27 offset:9648
    ds_read_b128 v[140:143], v27 offset:10160
    v_mfma_f32_16x16x32_bf16 v[36:39], v[80:83], v[100:103], 0
    ds_read_b128 v[144:147], v27 offset:10672
    ds_read_b128 v[148:151], v27 offset:11184
    v_mfma_f32_16x16x32_bf16 v[40:43], v[80:83], v[104:107], 0
    ds_read_b128 v[152:155], v27 offset:11696
    ds_read_b128 v[156:159], v27 offset:9584
    v_mfma_f32_16x16x32_bf16 v[44:47], v[80:83], v[108:111], 0
    ds_read_b128 v[160:163], v27 offset:10096
    v_mfma_f32_16x16x32_bf16 v[16:19], v[80:83], v[112:115], 0
    s_waitcnt lgkmcnt(7)
    v_mfma_f32_16x16x32_bf16 v[32:35], v[84:87], v[116:119], v[32:35]
    ds_read_b128 v[164:167], v27 offset:10608
    v_mfma_f32_16x16x32_bf16 v[36:39], v[84:87], v[120:123], v[36:39]
    ds_read_b128 v[64:67], v27 offset:11120
    ds_read_b128 v[68:71], v27 offset:11632
    v_mfma_f32_16x16x32_bf16 v[40:43], v[84:87], v[124:127], v[40:43]
    ds_read_b64 v[72:73], v24 offset:256
    v_mfma_f32_16x16x32_bf16 v[44:47], v[84:87], v[128:131], v[44:47]
    ds_read_b64 v[74:75], v24 offset:264
    v_mfma_f32_16x16x32_bf16 v[16:19], v[84:87], v[132:135], v[16:19]
    ds_read_b128 v[76:79], v27 offset:9520
    s_waitcnt lgkmcnt(8)
    v_mfma_f32_16x16x32_bf16 v[32:35], v[88:91], v[136:139], v[32:35]
    ds_read_b128 v[4:7], v27 offset:10032
    v_mfma_f32_16x16x32_bf16 v[36:39], v[88:91], v[140:143], v[36:39]
    ds_read_b128 v[8:11], v27 offset:10544
    ds_read_b128 v[12:15], v27 offset:11056
    v_mfma_f32_16x16x32_bf16 v[40:43], v[88:91], v[144:147], v[40:43]
    ds_read_b128 v[48:51], v27 offset:11568
    ds_read_b64 v[52:53], v24 offset:320
    v_mfma_f32_16x16x32_bf16 v[44:47], v[88:91], v[148:151], v[44:47]
    ds_read_b64 v[54:55], v24 offset:328
    v_mfma_f32_16x16x32_bf16 v[16:19], v[88:91], v[152:155], v[16:19]
    s_waitcnt lgkmcnt(8)
    v_mfma_f32_16x16x32_bf16 v[32:35], v[92:95], v[156:159], v[32:35]
    ds_read_b128 v[56:59], v27 offset:9456
    v_mfma_f32_16x16x32_bf16 v[36:39], v[92:95], v[160:163], v[36:39]
    ds_read_b128 v[60:63], v27 offset:9968
    ds_read_b128 v[104:107], v27 offset:10480
    v_mfma_f32_16x16x32_bf16 v[40:43], v[92:95], v[164:167], v[40:43]
    ds_read_b128 v[80:83], v27 offset:10992
    ds_read_b128 v[112:115], v27 offset:11504
    v_mfma_f32_16x16x32_bf16 v[44:47], v[92:95], v[64:67], v[44:47]
    ds_read_b64 v[124:125], v24 offset:384
    v_mfma_f32_16x16x32_bf16 v[16:19], v[92:95], v[68:71], v[16:19]
    s_waitcnt lgkmcnt(8)
    v_mfma_f32_16x16x32_bf16 v[32:35], v[72:75], v[76:79], v[32:35]
    ds_read_b64 v[126:127], v24 offset:392
    v_mfma_f32_16x16x32_bf16 v[36:39], v[72:75], v[4:7], v[36:39]
    ds_read_b128 v[84:87], v27 offset:9392
    ds_read_b128 v[132:135], v27 offset:9904
    v_mfma_f32_16x16x32_bf16 v[40:43], v[72:75], v[8:11], v[40:43]
    ds_read_b128 v[144:147], v27 offset:10416
    ds_read_b128 v[88:91], v27 offset:10928
    v_mfma_f32_16x16x32_bf16 v[44:47], v[72:75], v[12:15], v[44:47]
    ds_read_b128 v[152:155], v27 offset:11440
    v_mfma_f32_16x16x32_bf16 v[16:19], v[72:75], v[48:51], v[16:19]
    s_waitcnt lgkmcnt(7)
    v_mfma_f32_16x16x32_bf16 v[32:35], v[52:55], v[56:59], v[32:35]
    ds_read_b64 v[164:165], v24 offset:448
    v_mfma_f32_16x16x32_bf16 v[36:39], v[52:55], v[60:63], v[36:39]
    ds_read_b64 v[166:167], v24 offset:456
    ds_read_b128 v[92:95], v27 offset:9328
    v_mfma_f32_16x16x32_bf16 v[40:43], v[52:55], v[104:107], v[40:43]
    ds_read_b128 v[68:71], v27 offset:9840
    ds_read_b128 v[8:11], v27 offset:10352
    v_mfma_f32_16x16x32_bf16 v[44:47], v[52:55], v[80:83], v[44:47]
    ds_read_b128 v[72:75], v27 offset:10864
    ds_read_b128 v[48:51], v27 offset:11376
    v_mfma_f32_16x16x32_bf16 v[16:19], v[52:55], v[112:115], v[16:19]
    s_waitcnt lgkmcnt(7)
    v_mfma_f32_16x16x32_bf16 v[32:35], v[124:127], v[84:87], v[32:35]
    ds_read_b64 v[104:105], v24 offset:512
    v_mfma_f32_16x16x32_bf16 v[36:39], v[124:127], v[132:135], v[36:39]
    ds_read_b64 v[106:107], v24 offset:520
    ds_read_b128 v[52:55], v27 offset:10800
    v_mfma_f32_16x16x32_bf16 v[40:43], v[124:127], v[144:147], v[40:43]
    ds_read_b64 v[112:113], v24 offset:576
    v_mfma_f32_16x16x32_bf16 v[44:47], v[124:127], v[88:91], v[44:47]
    ds_read_b64 v[114:115], v24 offset:584
    v_mfma_f32_16x16x32_bf16 v[16:19], v[124:127], v[152:155], v[16:19]
    ds_read_b128 v[144:147], v27 offset:10736
    s_waitcnt lgkmcnt(6)
    v_mfma_f32_16x16x32_bf16 v[32:35], v[164:167], v[92:95], v[32:35]
    ds_read_b64 v[124:125], v24 offset:640
    v_mfma_f32_16x16x32_bf16 v[36:39], v[164:167], v[68:71], v[36:39]
    ds_read_b64 v[126:127], v24 offset:648
    v_mfma_f32_16x16x32_bf16 v[40:43], v[164:167], v[8:11], v[40:43]
    ds_read_b128 v[152:155], v27 offset:10672
    v_mfma_f32_16x16x32_bf16 v[44:47], v[164:167], v[72:75], v[44:47]
    ds_read_b64 v[8:9], v24 offset:704
    v_mfma_f32_16x16x32_bf16 v[16:19], v[164:167], v[48:51], v[16:19]
    v_cvt_pk_bf16_f32 v32, v32, v33
    v_cvt_pk_bf16_f32 v33, v34, v35
    ds_write_b64 v28, v[32:33] offset:22400
    s_waitcnt lgkmcnt(8)
    v_mfma_f32_16x16x32_bf16 v[36:39], v[104:107], v[96:99], v[36:39]
    ds_read_b64 v[10:11], v24 offset:712
    v_mfma_f32_16x16x32_bf16 v[40:43], v[104:107], v[100:103], v[40:43]
    ds_read_b128 v[164:167], v27 offset:10608
    v_mfma_f32_16x16x32_bf16 v[44:47], v[104:107], v[52:55], v[44:47]
    ds_read_b64 v[48:49], v24 offset:768
    v_mfma_f32_16x16x32_bf16 v[16:19], v[104:107], v[108:111], v[16:19]
    ds_read_b64 v[50:51], v24 offset:776
    s_waitcnt lgkmcnt(8)
    v_mfma_f32_16x16x32_bf16 v[36:39], v[112:115], v[116:119], v[36:39]
    ds_read_b128 v[100:103], v27 offset:10544
    v_mfma_f32_16x16x32_bf16 v[40:43], v[112:115], v[120:123], v[40:43]
    ds_read_b64 v[104:105], v24 offset:832
    v_mfma_f32_16x16x32_bf16 v[44:47], v[112:115], v[144:147], v[44:47]
    ds_read_b64 v[106:107], v24 offset:840
    v_mfma_f32_16x16x32_bf16 v[16:19], v[112:115], v[128:131], v[16:19]
    ds_read_b128 v[108:111], v27 offset:10480
    s_waitcnt lgkmcnt(8)
    v_mfma_f32_16x16x32_bf16 v[36:39], v[124:127], v[136:139], v[36:39]
    s_barrier
    v_mfma_f32_16x16x32_bf16 v[40:43], v[124:127], v[140:143], v[40:43]
    ds_read_b64 v[120:121], v24 offset:896
    v_mfma_f32_16x16x32_bf16 v[44:47], v[124:127], v[152:155], v[44:47]
    ds_read_b64 v[122:123], v24 offset:904
    v_mfma_f32_16x16x32_bf16 v[16:19], v[124:127], v[148:151], v[16:19]
    ds_read_b128 v[112:115], v27 offset:10416
    s_waitcnt lgkmcnt(9)
    v_mfma_f32_16x16x32_bf16 v[36:39], v[8:11], v[156:159], v[36:39]
    ds_read_b64 v[128:129], v24 offset:960
    v_mfma_f32_16x16x32_bf16 v[40:43], v[8:11], v[160:163], v[40:43]
    ds_read_b64 v[130:131], v24 offset:968
    v_mfma_f32_16x16x32_bf16 v[44:47], v[8:11], v[164:167], v[44:47]
    ds_read_b128 v[140:143], v27 offset:10352
    v_mfma_f32_16x16x32_bf16 v[16:19], v[8:11], v[64:67], v[16:19]
    ds_read_b64 v[124:125], v24 offset:1024
    s_waitcnt lgkmcnt(8)
    v_mfma_f32_16x16x32_bf16 v[36:39], v[48:51], v[76:79], v[36:39]
    ds_read_b64 v[126:127], v24 offset:1032
    v_mfma_f32_16x16x32_bf16 v[40:43], v[48:51], v[4:7], v[40:43]
    ds_read_b128 v[148:151], v27 offset:10288
    v_mfma_f32_16x16x32_bf16 v[44:47], v[48:51], v[100:103], v[44:47]
    ds_read_b64 v[160:161], v24 offset:1088
    v_mfma_f32_16x16x32_bf16 v[16:19], v[48:51], v[12:15], v[16:19]
    ds_read_b64 v[162:163], v24 offset:1096
    s_waitcnt lgkmcnt(8)
    v_mfma_f32_16x16x32_bf16 v[36:39], v[104:107], v[56:59], v[36:39]
    ds_read_b128 v[8:11], v27 offset:10224
    v_mfma_f32_16x16x32_bf16 v[40:43], v[104:107], v[60:63], v[40:43]
    ds_read_b64 v[64:65], v24 offset:1152
    v_mfma_f32_16x16x32_bf16 v[44:47], v[104:107], v[108:111], v[44:47]
    ds_read_b64 v[66:67], v24 offset:1160
    v_mfma_f32_16x16x32_bf16 v[16:19], v[104:107], v[80:83], v[16:19]
    ds_read_b128 v[4:7], v27 offset:10160
    s_waitcnt lgkmcnt(8)
    v_mfma_f32_16x16x32_bf16 v[36:39], v[120:123], v[84:87], v[36:39]
    ds_read_b64 v[48:49], v24 offset:1216
    v_mfma_f32_16x16x32_bf16 v[40:43], v[120:123], v[132:135], v[40:43]
    ds_read_b64 v[50:51], v24 offset:1224
    v_mfma_f32_16x16x32_bf16 v[44:47], v[120:123], v[112:115], v[44:47]
    ds_read_b128 v[12:15], v27 offset:10096
    v_mfma_f32_16x16x32_bf16 v[16:19], v[120:123], v[88:91], v[16:19]
    ds_read_b64 v[60:61], v24 offset:1280
    s_waitcnt lgkmcnt(8)
    v_mfma_f32_16x16x32_bf16 v[36:39], v[128:131], v[92:95], v[36:39]
    ds_read_b64 v[62:63], v24 offset:1288
    v_mfma_f32_16x16x32_bf16 v[40:43], v[128:131], v[68:71], v[40:43]
    ds_read_b128 v[104:107], v27 offset:10032
    v_mfma_f32_16x16x32_bf16 v[44:47], v[128:131], v[140:143], v[44:47]
    ds_read_b64 v[80:81], v24 offset:1344
    v_mfma_f32_16x16x32_bf16 v[16:19], v[128:131], v[72:75], v[16:19]
    ds_read_b64 v[82:83], v24 offset:1352
    s_waitcnt lgkmcnt(8)
    v_mfma_f32_16x16x32_bf16 v[40:43], v[124:127], v[96:99], v[40:43]
    v_cvt_pk_bf16_f32 v36, v36, v37
    v_cvt_pk_bf16_f32 v37, v38, v39
    ds_write_b64 v28, v[36:37] offset:22976
    v_mfma_f32_16x16x32_bf16 v[44:47], v[124:127], v[148:151], v[44:47]
    ds_read_b128 v[132:135], v27 offset:9968
    v_mfma_f32_16x16x32_bf16 v[16:19], v[124:127], v[52:55], v[16:19]
    ds_read_b64 v[120:121], v24 offset:1408
    v_mfma_f32_16x16x32_bf16 v[40:43], v[160:163], v[116:119], v[40:43]
    ds_read_b64 v[122:123], v24 offset:1416
    v_mfma_f32_16x16x32_bf16 v[44:47], v[160:163], v[8:11], v[44:47]
    ds_read_b128 v[88:91], v27 offset:9904
    v_mfma_f32_16x16x32_bf16 v[16:19], v[160:163], v[144:147], v[16:19]
    ds_read_b64 v[68:69], v24 offset:1472
    s_waitcnt lgkmcnt(8)
    v_mfma_f32_16x16x32_bf16 v[40:43], v[64:67], v[136:139], v[40:43]
    ds_read_b64 v[70:71], v24 offset:1480
    v_mfma_f32_16x16x32_bf16 v[44:47], v[64:67], v[4:7], v[44:47]
    ds_read_b128 v[128:131], v27 offset:9840
    v_mfma_f32_16x16x32_bf16 v[16:19], v[64:67], v[152:155], v[16:19]
    ds_read_b64 v[72:73], v24 offset:1536
    v_mfma_f32_16x16x32_bf16 v[40:43], v[48:51], v[156:159], v[40:43]
    s_waitcnt lgkmcnt(8)
    s_barrier
    v_mfma_f32_16x16x32_bf16 v[44:47], v[48:51], v[12:15], v[44:47]
    ds_read_b64 v[74:75], v24 offset:1544
    v_mfma_f32_16x16x32_bf16 v[16:19], v[48:51], v[164:167], v[16:19]
    ds_read_b128 v[96:99], v27 offset:9776
    v_mfma_f32_16x16x32_bf16 v[40:43], v[60:63], v[76:79], v[40:43]
    ds_read_b64 v[124:125], v24 offset:1600
    v_mfma_f32_16x16x32_bf16 v[44:47], v[60:63], v[104:107], v[44:47]
    ds_read_b64 v[126:127], v24 offset:1608
    v_mfma_f32_16x16x32_bf16 v[16:19], v[60:63], v[100:103], v[16:19]
    ds_read_b128 v[52:55], v27 offset:9712
    s_waitcnt lgkmcnt(8)
    v_mfma_f32_16x16x32_bf16 v[40:43], v[80:83], v[56:59], v[40:43]
    ds_read_b64 v[116:117], v24 offset:1664
    v_mfma_f32_16x16x32_bf16 v[44:47], v[80:83], v[132:135], v[44:47]
    ds_read_b64 v[118:119], v24 offset:1672
    v_mfma_f32_16x16x32_bf16 v[16:19], v[80:83], v[108:111], v[16:19]
    ds_read_b128 v[160:163], v27 offset:9648
    v_mfma_f32_16x16x32_bf16 v[40:43], v[120:123], v[84:87], v[40:43]
    ds_read_b64 v[144:145], v24 offset:1728
    v_mfma_f32_16x16x32_bf16 v[44:47], v[120:123], v[88:91], v[44:47]
    ds_read_b64 v[146:147], v24 offset:1736
    v_mfma_f32_16x16x32_bf16 v[16:19], v[120:123], v[112:115], v[16:19]
    ds_read_b128 v[136:139], v27 offset:9584
    s_waitcnt lgkmcnt(8)
    v_mfma_f32_16x16x32_bf16 v[40:43], v[68:71], v[92:95], v[40:43]
    ds_read_b64 v[64:65], v24 offset:1792
    v_mfma_f32_16x16x32_bf16 v[44:47], v[68:71], v[128:131], v[44:47]
    ds_read_b64 v[66:67], v24 offset:1800
    v_mfma_f32_16x16x32_bf16 v[16:19], v[68:71], v[140:143], v[16:19]
    ds_read_b128 v[152:155], v27 offset:9520
    ds_read_b64 v[156:157], v24 offset:1856
    s_waitcnt lgkmcnt(8)
    v_mfma_f32_16x16x32_bf16 v[44:47], v[72:75], v[96:99], v[44:47]
    ds_read_b64 v[158:159], v24 offset:1864
    v_mfma_f32_16x16x32_bf16 v[16:19], v[72:75], v[148:151], v[16:19]
    v_cvt_pk_bf16_f32 v40, v40, v41
    v_cvt_pk_bf16_f32 v41, v42, v43
    ds_write_b64 v28, v[40:41] offset:23552
    v_mfma_f32_16x16x32_bf16 v[44:47], v[124:127], v[52:55], v[44:47]
    ds_read_b128 v[48:51], v27 offset:9456
    ds_read_b64 v[164:165], v24 offset:1920
    v_mfma_f32_16x16x32_bf16 v[16:19], v[124:127], v[8:11], v[16:19]
    ds_read_b64 v[166:167], v24 offset:1928
    ds_read_b128 v[76:79], v27 offset:9392
    s_waitcnt lgkmcnt(8)
    v_mfma_f32_16x16x32_bf16 v[44:47], v[116:119], v[160:163], v[44:47]
    ds_read_b64 v[60:61], v24 offset:1984
    v_mfma_f32_16x16x32_bf16 v[16:19], v[116:119], v[4:7], v[16:19]
    ds_read_b64 v[62:63], v24 offset:1992
    ds_read_b128 v[100:103], v27 offset:9328
    v_mfma_f32_16x16x32_bf16 v[44:47], v[144:147], v[136:139], v[44:47]
    v_mfma_f32_16x16x32_bf16 v[16:19], v[144:147], v[12:15], v[16:19]
    s_waitcnt lgkmcnt(10)
    v_mfma_f32_16x16x32_bf16 v[44:47], v[64:67], v[152:155], v[44:47]
    v_mfma_f32_16x16x32_bf16 v[16:19], v[64:67], v[104:107], v[16:19]
    s_waitcnt lgkmcnt(6)
    v_mfma_f32_16x16x32_bf16 v[44:47], v[156:159], v[48:51], v[44:47]
    s_barrier
    s_barrier
    v_mfma_f32_16x16x32_bf16 v[16:19], v[156:159], v[132:135], v[16:19]
    ds_read_b64 v[56:57], v25 offset:2048
    ds_read_b64 v[58:59], v26 offset:2056
    ds_read_b64 v[80:81], v24 offset:13992
    s_waitcnt lgkmcnt(6)
    v_mfma_f32_16x16x32_bf16 v[44:47], v[164:167], v[76:79], v[44:47]
    ds_read_b64 v[82:83], v24 offset:14000
    ds_read_b64 v[108:109], v24 offset:14056
    ds_read_b64 v[110:111], v24 offset:14064
    v_mfma_f32_16x16x32_bf16 v[16:19], v[164:167], v[88:91], v[16:19]
    ds_read_b64 v[84:85], v24 offset:14120
    ds_read_b64 v[86:87], v24 offset:14128
    s_waitcnt lgkmcnt(8)
    v_mfma_f32_16x16x32_bf16 v[44:47], v[60:63], v[100:103], v[44:47]
    ds_read_b64 v[120:121], v24 offset:14184
    ds_read_b64 v[122:123], v24 offset:14192
    v_mfma_f32_16x16x32_bf16 v[16:19], v[60:63], v[128:131], v[16:19]
    ds_read_b64 v[112:113], v24 offset:14248
    ds_read_b64 v[114:115], v24 offset:14256
    s_waitcnt lgkmcnt(8)
    v_mfma_f32_16x16x32_bf16 v[16:19], v[56:59], v[96:99], v[16:19]
    ds_read_b64 v[92:93], v24 offset:14312
    ds_read_b64 v[94:95], v24 offset:14320
    v_mfma_f32_16x16x32_bf16 v[16:19], v[80:83], v[52:55], v[16:19]
    ds_read_b64 v[68:69], v24 offset:14376
    ds_read_b64 v[70:71], v24 offset:14384
    s_waitcnt lgkmcnt(8)
    v_mfma_f32_16x16x32_bf16 v[16:19], v[108:111], v[160:163], v[16:19]
    v_cvt_pk_bf16_f32 v44, v44, v45
    v_cvt_pk_bf16_f32 v45, v46, v47
    ds_write_b64 v28, v[44:45] offset:24128
    v_mfma_f32_16x16x32_bf16 v[16:19], v[84:87], v[136:139], v[16:19]
    s_waitcnt lgkmcnt(7)
    v_mfma_f32_16x16x32_bf16 v[16:19], v[120:123], v[152:155], v[16:19]
    s_waitcnt lgkmcnt(5)
    v_mfma_f32_16x16x32_bf16 v[16:19], v[112:115], v[48:51], v[16:19]
    s_waitcnt lgkmcnt(3)
    v_mfma_f32_16x16x32_bf16 v[16:19], v[92:95], v[76:79], v[16:19]
    s_waitcnt lgkmcnt(1)
    v_mfma_f32_16x16x32_bf16 v[16:19], v[68:71], v[100:103], v[16:19]
    s_waitcnt lgkmcnt(0)
    s_barrier
    s_nop 5
    v_cvt_pk_bf16_f32 v16, v16, v17
    v_cvt_pk_bf16_f32 v17, v18, v19
    ds_write_b64 v28, v[16:17] offset:24704
    s_waitcnt lgkmcnt(0)
    s_barrier
    s_branch L_fin
L_E1:
    v_lshl_add_u32 v20, v0, 3, s27
    s_waitcnt vmcnt(0)
    s_mov_b32 s44, 0x3fb8aa3b
    s_mov_b32 s45, 0x32a57060
    s_mov_b32 s46, 0x3f317218
    v_lshlrev_b32 v30, 16, v4
    v_and_b32 v31, 0xffff0000, v4
    v_lshlrev_b32 v34, 16, v6
    v_mul_f32 v35, s44, v30
    v_mul_f32 v36, s44, v31
    v_mul_f32 v37, s44, v34
    v_fma_f32 v38, v30, s44, -v35
    v_fma_f32 v39, v31, s44, -v36
    v_fma_f32 v40, v34, s44, -v37
    v_exp_f32 v35, v35
    v_exp_f32 v36, v36
    v_exp_f32 v37, v37
    v_fmac_f32 v38, s45, v30
    v_fmac_f32 v39, s45, v31
    v_fmac_f32 v40, s45, v34
    v_mul_f32 v38, s46, v38
    v_mul_f32 v39, s46, v39
    v_mul_f32 v40, s46, v40
    v_fmac_f32 v35, v35, v38
    v_fmac_f32 v36, v36, v39
    v_fmac_f32 v37, v37, v40
    v_cvt_pk_bf16_f32 v37, v37, v37
    v_cvt_pk_bf16_f32 v35, v35, v36
    v_lshlrev_b32 v32, 16, v5
    v_and_b32 v33, 0xffff0000, v5
    v_lshlrev_b32 v34, 16, v37
    v_lshlrev_b32 v30, 16, v35
    v_and_b32 v31, 0xffff0000, v35
    v_mul_f32 v30, v30, v34
    v_mul_f32 v31, v31, v34
    v_mul_f32 v32, v32, v34
    v_mul_f32 v33, v33, v34
    v_mul_f32 v30, 0xbfb8aa3b, v30
    v_mul_f32 v31, 0xbfb8aa3b, v31
    v_mul_f32 v32, 0xbe22f983, v32
    v_mul_f32 v33, 0xbe22f983, v33
    v_mul_f32 v40, 0x43800000, v30
    v_mul_f32 v41, 0x43800000, v32
    v_mul_f32 v42, 0x43800000, v31
    v_mul_f32 v43, 0x43800000, v33
    v_fract_f32 v37, v32
    v_fract_f32 v39, v33
    v_fract_f32 v41, v41
    v_fract_f32 v43, v43
    v_exp_f32 v36, v30
    v_exp_f32 v38, v31
    v_exp_f32 v40, v40
    v_exp_f32 v42, v42
    v_cos_f32 v52, v37
    v_sin_f32 v53, v37
    v_cos_f32 v54, v39
    v_sin_f32 v55, v39
    v_cos_f32 v56, v41
    v_sin_f32 v57, v41
    v_cos_f32 v58, v43
    v_sin_f32 v59, v43
    s_nop 0
    v_mul_f32 v52, v52, v36
    v_mul_f32 v53, v53, v36
    v_mul_f32 v54, v54, v38
    v_mul_f32 v55, v55, v38
    v_mul_f32 v56, v56, v40
    v_mul_f32 v57, v57, v40
    v_mul_f32 v58, v58, v42
    v_mul_f32 v59, v59, v42
    v_add_f32 v34, v34, v34
    v_lshlrev_b32 v72, 16, v7
    v_and_b32 v74, 0xffff0000, v7
    v_lshlrev_b32 v73, 16, v8
    v_and_b32 v75, 0xffff0000, v8
    v_mul_f32 v72, v72, v34
    v_mul_f32 v74, v74, v34
    v_mul_f32 v73, -v73, v34
    v_mul_f32 v75, -v75, v34
    v_pk_mul_f32 v[60:61], v[52:53], v[52:53] op_sel_hi:[0,1]
    v_pk_mul_f32 v[62:63], v[54:55], v[54:55] op_sel_hi:[0,1]
    v_pk_fma_f32 v[60:61], v[52:53], v[52:53], v[60:61] op_sel:[1,1,0] op_sel_hi:[1,0,1] neg_lo:[1,0,0]
    v_pk_fma_f32 v[62:63], v[54:55], v[54:55], v[62:63] op_sel:[1,1,0] op_sel_hi:[1,0,1] neg_lo:[1,0,0]
    v_cvt_pk_bf16_f32 v44, v72, v73
    v_cvt_pk_bf16_f32 v45, v74, v75
    ds_write_b64 v20, v[44:45] offset:26704
    v_pk_mul_f32 v[64:65], v[60:61], v[60:61] op_sel_hi:[0,1]
    v_pk_mul_f32 v[66:67], v[62:63], v[62:63] op_sel_hi:[0,1]
    v_pk_fma_f32 v[64:65], v[60:61], v[60:61], v[64:65] op_sel:[1,1,0] op_sel_hi:[1,0,1] neg_lo:[1,0,0]
    v_pk_fma_f32 v[66:67], v[62:63], v[62:63], v[66:67] op_sel:[1,1,0] op_sel_hi:[1,0,1] neg_lo:[1,0,0]
    v_pk_mul_f32 v[80:81], v[72:73], v[52:53] op_sel_hi:[0,1]
    v_pk_mul_f32 v[82:83], v[74:75], v[54:55] op_sel_hi:[0,1]
    v_pk_fma_f32 v[80:81], v[72:73], v[52:53], v[80:81] op_sel:[1,1,0] op_sel_hi:[1,0,1] neg_lo:[1,0,0]
    v_pk_fma_f32 v[82:83], v[74:75], v[54:55], v[82:83] op_sel:[1,1,0] op_sel_hi:[1,0,1] neg_lo:[1,0,0]
    v_pk_mul_f32 v[68:69], v[64:65], v[64:65] op_sel_hi:[0,1]
    v_pk_mul_f32 v[70:71], v[66:67], v[66:67] op_sel_hi:[0,1]
    v_pk_fma_f32 v[68:69], v[64:65], v[64:65], v[68:69] op_sel:[1,1,0] op_sel_hi:[1,0,1] neg_lo:[1,0,0]
    v_pk_fma_f32 v[70:71], v[66:67], v[66:67], v[70:71] op_sel:[1,1,0] op_sel_hi:[1,0,1] neg_lo:[1,0,0]
    v_cvt_pk_bf16_f32 v46, v80, v81
    v_cvt_pk_bf16_f32 v47, v82, v83
    ds_write_b64 v20, v[46:47] offset:27232
    v_pk_mul_f32 v[76:77], v[80:81], v[52:53] op_sel_hi:[0,1]
    v_pk_mul_f32 v[78:79], v[82:83], v[54:55] op_sel_hi:[0,1]
    v_pk_fma_f32 v[76:77], v[80:81], v[52:53], v[76:77] op_sel:[1,1,0] op_sel_hi:[1,0,1] neg_lo:[1,0,0]
    v_pk_fma_f32 v[78:79], v[82:83], v[54:55], v[78:79] op_sel:[1,1,0] op_sel_hi:[1,0,1] neg_lo:[1,0,0]
    v_cvt_pk_bf16_f32 v48, v76, v77
    v_cvt_pk_bf16_f32 v49, v78, v79
    ds_write_b64 v20, v[48:49] offset:27760
    v_pk_mul_f32 v[80:81], v[76:77], v[52:53] op_sel_hi:[0,1]
    v_pk_mul_f32 v[82:83], v[78:79], v[54:55] op_sel_hi:[0,1]
    v_pk_fma_f32 v[80:81], v[76:77], v[52:53], v[80:81] op_sel:[1,1,0] op_sel_hi:[1,0,1] neg_lo:[1,0,0]
    v_pk_fma_f32 v[82:83], v[78:79], v[54:55], v[82:83] op_sel:[1,1,0] op_sel_hi:[1,0,1] neg_lo:[1,0,0]
    v_cvt_pk_bf16_f32 v44, v80, v81
    v_cvt_pk_bf16_f32 v45, v82, v83
    ds_write_b64 v20, v[44:45] offset:28288
    v_pk_mul_f32 v[76:77], v[80:81], v[52:53] op_sel_hi:[0,1]
    v_pk_mul_f32 v[78:79], v[82:83], v[54:55] op_sel_hi:[0,1]
    v_pk_fma_f32 v[76:77], v[80:81], v[52:53], v[76:77] op_sel:[1,1,0] op_sel_hi:[1,0,1] neg_lo:[1,0,0]
    v_pk_fma_f32 v[78:79], v[82:83], v[54:55], v[78:79] op_sel:[1,1,0] op_sel_hi:[1,0,1] neg_lo:[1,0,0]
    v_cvt_pk_bf16_f32 v46, v76, v77
    v_cvt_pk_bf16_f32 v47, v78, v79
    ds_write_b64 v20, v[46:47] offset:36208
    v_pk_mul_f32 v[80:81], v[76:77], v[52:53] op_sel_hi:[0,1]
    v_pk_mul_f32 v[82:83], v[78:79], v[54:55] op_sel_hi:[0,1]
    v_pk_fma_f32 v[80:81], v[76:77], v[52:53], v[80:81] op_sel:[1,1,0] op_sel_hi:[1,0,1] neg_lo:[1,0,0]
    v_pk_fma_f32 v[82:83], v[78:79], v[54:55], v[82:83] op_sel:[1,1,0] op_sel_hi:[1,0,1] neg_lo:[1,0,0]
    v_cvt_pk_bf16_f32 v48, v80, v81
    v_cvt_pk_bf16_f32 v49, v82, v83
    ds_write_b64 v20, v[48:49] offset:36736
    v_pk_mul_f32 v[76:77], v[80:81], v[52:53] op_sel_hi:[0,1]
    v_pk_mul_f32 v[78:79], v[82:83], v[54:55] op_sel_hi:[0,1]
    v_pk_fma_f32 v[76:77], v[80:81], v[52:53], v[76:77] op_sel:[1,1,0] op_sel_hi:[1,0,1] neg_lo:[1,0,0]
    v_pk_fma_f32 v[78:79], v[82:83], v[54:55], v[78:79] op_sel:[1,1,0] op_sel_hi:[1,0,1] neg_lo:[1,0,0]
    v_cvt_pk_bf16_f32 v44, v76, v77
    v_cvt_pk_bf16_f32 v45, v78, v79
    ds_write_b64 v20, v[44:45] offset:37264
    v_pk_mul_f32 v[80:81], v[76:77], v[52:53] op_sel_hi:[0,1]
    v_pk_mul_f32 v[82:83], v[78:79], v[54:55] op_sel_hi:[0,1]
    v_pk_fma_f32 v[80:81], v[76:77], v[52:53], v[80:81] op_sel:[1,1,0] op_sel_hi:[1,0,1] neg_lo:[1,0,0]
    v_pk_fma_f32 v[82:83], v[78:79], v[54:55], v[82:83] op_sel:[1,1,0] op_sel_hi:[1,0,1] neg_lo:[1,0,0]
    v_cvt_pk_bf16_f32 v46, v80, v81
    v_cvt_pk_bf16_f32 v47, v82, v83
    ds_write_b64 v20, v[46:47] offset:37792
    v_pk_mul_f32 v[88:89], v[72:73], v[56:57] op_sel_hi:[0,1]
    v_pk_mul_f32 v[90:91], v[74:75], v[58:59] op_sel_hi:[0,1]
    v_pk_fma_f32 v[88:89], v[72:73], v[56:57], v[88:89] op_sel:[1,1,0] op_sel_hi:[1,0,1] neg_lo:[1,0,0]
    v_pk_fma_f32 v[90:91], v[74:75], v[58:59], v[90:91] op_sel:[1,1,0] op_sel_hi:[1,0,1] neg_lo:[1,0,0]
    v_cvt_pk_bf16_f32 v48, v88, v89
    v_cvt_pk_bf16_f32 v49, v90, v91
    ds_write_b64 v20, v[48:49] offset:35152
    v_pk_mul_f32 v[76:77], v[88:89], v[60:61] op_sel_hi:[0,1]
    v_pk_mul_f32 v[78:79], v[90:91], v[62:63] op_sel_hi:[0,1]
    v_pk_fma_f32 v[76:77], v[88:89], v[60:61], v[76:77] op_sel:[1,1,0] op_sel_hi:[1,0,1] neg_lo:[1,0,0]
    v_pk_fma_f32 v[78:79], v[90:91], v[62:63], v[78:79] op_sel:[1,1,0] op_sel_hi:[1,0,1] neg_lo:[1,0,0]
    v_cvt_pk_bf16_f32 v44, v76, v77
    v_cvt_pk_bf16_f32 v45, v78, v79
    ds_write_b64 v20, v[44:45] offset:35680
    v_pk_mul_f32 v[80:81], v[88:89], v[64:65] op_sel_hi:[0,1]
    v_pk_mul_f32 v[82:83], v[90:91], v[66:67] op_sel_hi:[0,1]
    v_pk_fma_f32 v[80:81], v[88:89], v[64:65], v[80:81] op_sel:[1,1,0] op_sel_hi:[1,0,1] neg_lo:[1,0,0]
    v_pk_fma_f32 v[82:83], v[90:91], v[66:67], v[82:83] op_sel:[1,1,0] op_sel_hi:[1,0,1] neg_lo:[1,0,0]
    v_cvt_pk_bf16_f32 v46, v80, v81
    v_cvt_pk_bf16_f32 v47, v82, v83
    ds_write_b64 v20, v[46:47] offset:32512
    v_pk_mul_f32 v[76:77], v[80:81], v[60:61] op_sel_hi:[0,1]
    v_pk_mul_f32 v[78:79], v[82:83], v[62:63] op_sel_hi:[0,1]
    v_pk_fma_f32 v[76:77], v[80:81], v[60:61], v[76:77] op_sel:[1,1,0] op_sel_hi:[1,0,1] neg_lo:[1,0,0]
    v_pk_fma_f32 v[78:79], v[82:83], v[62:63], v[78:79] op_sel:[1,1,0] op_sel_hi:[1,0,1] neg_lo:[1,0,0]
    v_cvt_pk_bf16_f32 v48, v76, v77
    v_cvt_pk_bf16_f32 v49, v78, v79
    ds_write_b64 v20, v[48:49] offset:28816
    v_pk_mul_f32 v[80:81], v[88:89], v[68:69] op_sel_hi:[0,1]
    v_pk_mul_f32 v[82:83], v[90:91], v[70:71] op_sel_hi:[0,1]
    v_pk_fma_f32 v[80:81], v[88:89], v[68:69], v[80:81] op_sel:[1,1,0] op_sel_hi:[1,0,1] neg_lo:[1,0,0]
    v_pk_fma_f32 v[82:83], v[90:91], v[70:71], v[82:83] op_sel:[1,1,0] op_sel_hi:[1,0,1] neg_lo:[1,0,0]
    v_cvt_pk_bf16_f32 v44, v80, v81
    v_cvt_pk_bf16_f32 v45, v82, v83
    ds_write_b64 v20, v[44:45] offset:29344
    v_pk_mul_f32 v[84:85], v[88:89], v[56:57] op_sel_hi:[0,1]
    v_pk_mul_f32 v[86:87], v[90:91], v[58:59] op_sel_hi:[0,1]
    v_pk_fma_f32 v[84:85], v[88:89], v[56:57], v[84:85] op_sel:[1,1,0] op_sel_hi:[1,0,1] neg_lo:[1,0,0]
    v_pk_fma_f32 v[86:87], v[90:91], v[58:59], v[86:87] op_sel:[1,1,0] op_sel_hi:[1,0,1] neg_lo:[1,0,0]
    v_cvt_pk_bf16_f32 v46, v84, v85
    v_cvt_pk_bf16_f32 v47, v86, v87
    ds_write_b64 v20, v[46:47] offset:38320
    v_pk_mul_f32 v[76:77], v[84:85], v[64:65] op_sel_hi:[0,1]
    v_pk_mul_f32 v[78:79], v[86:87], v[66:67] op_sel_hi:[0,1]
    v_pk_fma_f32 v[76:77], v[84:85], v[64:65], v[76:77] op_sel:[1,1,0] op_sel_hi:[1,0,1] neg_lo:[1,0,0]
    v_pk_fma_f32 v[78:79], v[86:87], v[66:67], v[78:79] op_sel:[1,1,0] op_sel_hi:[1,0,1] neg_lo:[1,0,0]
    v_cvt_pk_bf16_f32 v48, v76, v77
    v_cvt_pk_bf16_f32 v49, v78, v79
    ds_write_b64 v20, v[48:49] offset:38848
    v_pk_mul_f32 v[80:81], v[84:85], v[68:69] op_sel_hi:[0,1]
    v_pk_mul_f32 v[82:83], v[86:87], v[70:71] op_sel_hi:[0,1]
    v_pk_fma_f32 v[80:81], v[84:85], v[68:69], v[80:81] op_sel:[1,1,0] op_sel_hi:[1,0,1] neg_lo:[1,0,0]
    v_pk_fma_f32 v[82:83], v[86:87], v[70:71], v[82:83] op_sel:[1,1,0] op_sel_hi:[1,0,1] neg_lo:[1,0,0]
    v_cvt_pk_bf16_f32 v44, v80, v81
    v_cvt_pk_bf16_f32 v45, v82, v83
    ds_write_b64 v20, v[44:45] offset:39376
    v_pk_mul_f32 v[88:89], v[84:85], v[56:57] op_sel_hi:[0,1]
    v_pk_mul_f32 v[90:91], v[86:87], v[58:59] op_sel_hi:[0,1]
    v_pk_fma_f32 v[88:89], v[84:85], v[56:57], v[88:89] op_sel:[1,1,0] op_sel_hi:[1,0,1] neg_lo:[1,0,0]
    v_pk_fma_f32 v[90:91], v[86:87], v[58:59], v[90:91] op_sel:[1,1,0] op_sel_hi:[1,0,1] neg_lo:[1,0,0]
    v_cvt_pk_bf16_f32 v46, v88, v89
    v_cvt_pk_bf16_f32 v47, v90, v91
    ds_write_b64 v20, v[46:47] offset:29872
    v_pk_mul_f32 v[76:77], v[88:89], v[64:65] op_sel_hi:[0,1]
    v_pk_mul_f32 v[78:79], v[90:91], v[66:67] op_sel_hi:[0,1]
    v_pk_fma_f32 v[76:77], v[88:89], v[64:65], v[76:77] op_sel:[1,1,0] op_sel_hi:[1,0,1] neg_lo:[1,0,0]
    v_pk_fma_f32 v[78:79], v[90:91], v[66:67], v[78:79] op_sel:[1,1,0] op_sel_hi:[1,0,1] neg_lo:[1,0,0]
    v_cvt_pk_bf16_f32 v48, v76, v77
    v_cvt_pk_bf16_f32 v49, v78, v79
    ds_write_b64 v20, v[48:49] offset:30400
    v_pk_mul_f32 v[80:81], v[88:89], v[68:69] op_sel_hi:[0,1]
    v_pk_mul_f32 v[82:83], v[90:91], v[70:71] op_sel_hi:[0,1]
    v_pk_fma_f32 v[80:81], v[88:89], v[68:69], v[80:81] op_sel:[1,1,0] op_sel_hi:[1,0,1] neg_lo:[1,0,0]
    v_pk_fma_f32 v[82:83], v[90:91], v[70:71], v[82:83] op_sel:[1,1,0] op_sel_hi:[1,0,1] neg_lo:[1,0,0]
    v_cvt_pk_bf16_f32 v44, v80, v81
    v_cvt_pk_bf16_f32 v45, v82, v83
    ds_write_b64 v20, v[44:45] offset:30928
    v_pk_mul_f32 v[84:85], v[88:89], v[56:57] op_sel_hi:[0,1]
    v_pk_mul_f32 v[86:87], v[90:91], v[58:59] op_sel_hi:[0,1]
    v_pk_fma_f32 v[84:85], v[88:89], v[56:57], v[84:85] op_sel:[1,1,0] op_sel_hi:[1,0,1] neg_lo:[1,0,0]
    v_pk_fma_f32 v[86:87], v[90:91], v[58:59], v[86:87] op_sel:[1,1,0] op_sel_hi:[1,0,1] neg_lo:[1,0,0]
    v_cvt_pk_bf16_f32 v46, v84, v85
    v_cvt_pk_bf16_f32 v47, v86, v87
    ds_write_b64 v20, v[46:47] offset:39904
    v_pk_mul_f32 v[80:81], v[84:85], v[68:69] op_sel_hi:[0,1]
    v_pk_mul_f32 v[82:83], v[86:87], v[70:71] op_sel_hi:[0,1]
    v_pk_fma_f32 v[80:81], v[84:85], v[68:69], v[80:81] op_sel:[1,1,0] op_sel_hi:[1,0,1] neg_lo:[1,0,0]
    v_pk_fma_f32 v[82:83], v[86:87], v[70:71], v[82:83] op_sel:[1,1,0] op_sel_hi:[1,0,1] neg_lo:[1,0,0]
    v_cvt_pk_bf16_f32 v48, v80, v81
    v_cvt_pk_bf16_f32 v49, v82, v83
    ds_write_b64 v20, v[48:49] offset:31984
    v_pk_mul_f32 v[88:89], v[84:85], v[56:57] op_sel_hi:[0,1]
    v_pk_mul_f32 v[90:91], v[86:87], v[58:59] op_sel_hi:[0,1]
    v_pk_fma_f32 v[88:89], v[84:85], v[56:57], v[88:89] op_sel:[1,1,0] op_sel_hi:[1,0,1] neg_lo:[1,0,0]
    v_pk_fma_f32 v[90:91], v[86:87], v[58:59], v[90:91] op_sel:[1,1,0] op_sel_hi:[1,0,1] neg_lo:[1,0,0]
    v_cvt_pk_bf16_f32 v44, v88, v89
    v_cvt_pk_bf16_f32 v45, v90, v91
    ds_write_b64 v20, v[44:45] offset:31456
    v_pk_mul_f32 v[80:81], v[88:89], v[68:69] op_sel_hi:[0,1]
    v_pk_mul_f32 v[82:83], v[90:91], v[70:71] op_sel_hi:[0,1]
    v_pk_fma_f32 v[80:81], v[88:89], v[68:69], v[80:81] op_sel:[1,1,0] op_sel_hi:[1,0,1] neg_lo:[1,0,0]
    v_pk_fma_f32 v[82:83], v[90:91], v[70:71], v[82:83] op_sel:[1,1,0] op_sel_hi:[1,0,1] neg_lo:[1,0,0]
    v_cvt_pk_bf16_f32 v46, v80, v81
    v_cvt_pk_bf16_f32 v47, v82, v83
    ds_write_b64 v20, v[46:47] offset:40432
    s_cmp_lg_u32 s7, 0
    s_cbranch_scc1 L_skipE
    v_pk_mul_f32 v[84:85], v[88:89], v[56:57] op_sel_hi:[0,1]
    v_pk_mul_f32 v[86:87], v[90:91], v[58:59] op_sel_hi:[0,1]
    v_pk_fma_f32 v[84:85], v[88:89], v[56:57], v[84:85] op_sel:[1,1,0] op_sel_hi:[1,0,1] neg_lo:[1,0,0]
    v_pk_fma_f32 v[86:87], v[90:91], v[58:59], v[86:87] op_sel:[1,1,0] op_sel_hi:[1,0,1] neg_lo:[1,0,0]
    v_cvt_pk_bf16_f32 v48, v84, v85
    v_cvt_pk_bf16_f32 v49, v86, v87
    ds_write_b64 v20, v[48:49] offset:33040
    v_pk_mul_f32 v[80:81], v[84:85], v[68:69] op_sel_hi:[0,1]
    v_pk_mul_f32 v[82:83], v[86:87], v[70:71] op_sel_hi:[0,1]
    v_pk_fma_f32 v[80:81], v[84:85], v[68:69], v[80:81] op_sel:[1,1,0] op_sel_hi:[1,0,1] neg_lo:[1,0,0]
    v_pk_fma_f32 v[82:83], v[86:87], v[70:71], v[82:83] op_sel:[1,1,0] op_sel_hi:[1,0,1] neg_lo:[1,0,0]
    v_cvt_pk_bf16_f32 v44, v80, v81
    v_cvt_pk_bf16_f32 v45, v82, v83
    ds_write_b64 v20, v[44:45] offset:33568
    v_pk_mul_f32 v[88:89], v[84:85], v[56:57] op_sel_hi:[0,1]
    v_pk_mul_f32 v[90:91], v[86:87], v[58:59] op_sel_hi:[0,1]
    v_pk_fma_f32 v[88:89], v[84:85], v[56:57], v[88:89] op_sel:[1,1,0] op_sel_hi:[1,0,1] neg_lo:[1,0,0]
    v_pk_fma_f32 v[90:91], v[86:87], v[58:59], v[90:91] op_sel:[1,1,0] op_sel_hi:[1,0,1] neg_lo:[1,0,0]
    v_cvt_pk_bf16_f32 v46, v88, v89
    v_cvt_pk_bf16_f32 v47, v90, v91
    ds_write_b64 v20, v[46:47] offset:34096
    v_pk_mul_f32 v[80:81], v[88:89], v[68:69] op_sel_hi:[0,1]
    v_pk_mul_f32 v[82:83], v[90:91], v[70:71] op_sel_hi:[0,1]
    v_pk_fma_f32 v[80:81], v[88:89], v[68:69], v[80:81] op_sel:[1,1,0] op_sel_hi:[1,0,1] neg_lo:[1,0,0]
    v_pk_fma_f32 v[82:83], v[90:91], v[70:71], v[82:83] op_sel:[1,1,0] op_sel_hi:[1,0,1] neg_lo:[1,0,0]
    v_cvt_pk_bf16_f32 v48, v80, v81
    v_cvt_pk_bf16_f32 v49, v82, v83
    ds_write_b64 v20, v[48:49] offset:34624
L_skipE:
    v_mov_b32 v30, s27
    v_mov_b32 v31, 1
    ds_write_b32 v30, v31 offset:9000
    s_waitcnt lgkmcnt(0)
    s_endpgm
L_L1:
    v_lshl_add_u32 v20, v0, 3, s27
    s_lshl_b32 s37, s24, 9
    v_lshl_add_u32 v21, v0, 3, s37
    v_add_u32 v22, 81920, v21
    v_bfe_u32 v13, v0, 2, 2
    v_mul_u32_u24 v13, 41024, v13
    v_and_b32 v14, 3, v0
    v_mul_u32_u24 v14, 144, v14
    v_lshrrev_b32 v15, 4, v0
    v_lshl_add_u32 v14, v15, 3, v14
    s_lshl_b32 s37, s24, 5
    v_add3_u32 v23, v13, v14, s37
    s_lshl_b32 s37, s24, 16
    s_add_u32 s37, s37, s3
    v_lshl_add_u32 v24, v0, 10, s37
    s_mov_b32 s48, 0x05040100
    s_mov_b32 s49, 0x07060302
    s_mov_b32 s52, s22
    s_and_b32 s53, s23, 0xffff
    s_mov_b32 s54, 2097152
    s_mov_b32 s55, 0x00020000
    s_load_dwordx2 s[56:57], s[40:41], 0
    s_load_dwordx2 s[58:59], s[40:41], 1024
    s_load_dwordx2 s[60:61], s[40:41], 2048
L_stage:
    v_add_u32 v26, 32, v21
    v_add_u32 v27, 2136, v21
    v_add_u32 v28, 4248, v21
    v_add_u32 v29, 6360, v21
    s_waitcnt lgkmcnt(0)
    s_cmp_eq_u32 s24, 0
    s_cselect_b32 s56, 0, s56
    s_cselect_b32 s57, 0, s57
    s_cselect_b32 s58, 0, s58
    s_cselect_b32 s59, 0, s59
    s_cselect_b32 s60, 0, s60
    s_cselect_b32 s61, 0, s61
    v_mov_b32 v96, s56
    v_mov_b32 v97, s57
    v_mov_b32 v98, s58
    v_mov_b32 v99, s59
    v_mov_b32 v100, s60
    v_mov_b32 v101, s61
    s_waitcnt vmcnt(0)
    s_nop 1
    v_mov_b32_dpp v96, v104 wave_shr:1 row_mask:0xf bank_mask:0xf
    v_mov_b32_dpp v97, v105 wave_shr:1 row_mask:0xf bank_mask:0xf
    v_mov_b32_dpp v98, v106 wave_shr:1 row_mask:0xf bank_mask:0xf
    v_mov_b32_dpp v99, v107 wave_shr:1 row_mask:0xf bank_mask:0xf
    v_mov_b32_dpp v100, v108 wave_shr:1 row_mask:0xf bank_mask:0xf
    v_mov_b32_dpp v101, v109 wave_shr:1 row_mask:0xf bank_mask:0xf
    v_perm_b32 v44, v104, v102, s48
    v_perm_b32 v45, v108, v106, s48
    v_perm_b32 v46, v104, v102, s49
    v_perm_b32 v47, v108, v106, s49
    ds_write2st64_b64 v26, v[44:45], v[46:47] offset0:0 offset1:80
    v_perm_b32 v48, v98, v96, s48
    v_perm_b32 v49, v102, v100, s48
    v_perm_b32 v50, v98, v96, s49
    v_perm_b32 v51, v102, v100, s49
    ds_write2st64_b64 v27, v[48:49], v[50:51] offset0:0 offset1:80
    v_perm_b32 v52, v100, v98, s48
    v_perm_b32 v53, v104, v102, s48
    v_perm_b32 v54, v100, v98, s49
    v_perm_b32 v55, v104, v102, s49
    ds_write2st64_b64 v28, v[52:53], v[54:55] offset0:0 offset1:80
    v_perm_b32 v56, v102, v100, s48
    v_perm_b32 v57, v106, v104, s48
    v_perm_b32 v58, v102, v100, s49
    v_perm_b32 v59, v106, v104, s49
    ds_write2st64_b64 v29, v[56:57], v[58:59] offset0:0 offset1:80
    v_perm_b32 v44, v105, v103, s48
    v_perm_b32 v45, v109, v107, s48
    v_perm_b32 v46, v105, v103, s49
    v_perm_b32 v47, v109, v107, s49
    ds_write2st64_b64 v26, v[44:45], v[46:47] offset0:160 offset1:240
    v_perm_b32 v48, v99, v97, s48
    v_perm_b32 v49, v103, v101, s48
    v_perm_b32 v50, v99, v97, s49
    v_perm_b32 v51, v103, v101, s49
    ds_write2st64_b64 v27, v[48:49], v[50:51] offset0:160 offset1:240
    v_perm_b32 v52, v101, v99, s48
    v_perm_b32 v53, v105, v103, s48
    v_perm_b32 v54, v101, v99, s49
    v_perm_b32 v55, v105, v103, s49
    ds_write2st64_b64 v28, v[52:53], v[54:55] offset0:160 offset1:240
    v_perm_b32 v56, v103, v101, s48
    v_perm_b32 v57, v107, v105, s48
    v_perm_b32 v58, v103, v101, s49
    v_perm_b32 v59, v107, v105, s49
    ds_write2st64_b64 v29, v[56:57], v[58:59] offset0:160 offset1:240
    s_cmp_eq_u32 s47, 1
    s_cbranch_scc1 L_rl1
    s_cmp_eq_u32 s47, 2
    s_cbranch_scc1 L_rl2
    s_cmp_eq_u32 s47, 3
    s_cbranch_scc1 L_rl3
    buffer_load_dwordx2 v[118:119], v9, s[28:31], s3 offen offset:0 nt
    buffer_load_dwordx2 v[120:121], v9, s[28:31], s3 offen offset:1024 nt
    buffer_load_dwordx2 v[122:123], v9, s[28:31], s3 offen offset:2048 nt
    buffer_load_dwordx2 v[124:125], v9, s[28:31], s3 offen offset:3072 nt
    s_branch L_rld
L_rl1:
    buffer_load_dwordx2 v[120:121], v9, s[28:31], s3 offen offset:1024 nt
    buffer_load_dwordx2 v[122:123], v9, s[28:31], s3 offen offset:2048 nt
    buffer_load_dwordx2 v[124:125], v9, s[28:31], s3 offen offset:3072 nt
    buffer_load_dwordx2 v[118:119], v9, s[28:31], s3 offen offset:0 nt
    s_branch L_rld
L_rl2:
    buffer_load_dwordx2 v[122:123], v9, s[28:31], s3 offen offset:2048 nt
    buffer_load_dwordx2 v[124:125], v9, s[28:31], s3 offen offset:3072 nt
    buffer_load_dwordx2 v[118:119], v9, s[28:31], s3 offen offset:0 nt
    buffer_load_dwordx2 v[120:121], v9, s[28:31], s3 offen offset:1024 nt
    s_branch L_rld
L_rl3:
    buffer_load_dwordx2 v[124:125], v9, s[28:31], s3 offen offset:3072 nt
    buffer_load_dwordx2 v[118:119], v9, s[28:31], s3 offen offset:0 nt
    buffer_load_dwordx2 v[120:121], v9, s[28:31], s3 offen offset:1024 nt
    buffer_load_dwordx2 v[122:123], v9, s[28:31], s3 offen offset:2048 nt
L_rld:
    s_waitcnt lgkmcnt(0)
    s_barrier
    s_cmp_eq_u32 s7, 0
    s_cbranch_scc1 L_hB
    s_barrier
    ds_read_b64_tr_b16 v[30:31], v23 offset:22400
    s_mov_b32 s37, 0
    s_waitcnt lgkmcnt(0)
    buffer_store_dwordx2 v[30:31], v24, s[52:55], s37 offen
    s_barrier
    ds_read_b64_tr_b16 v[32:33], v23 offset:22976
    s_mov_b32 s37, 262144
    s_waitcnt lgkmcnt(0)
    buffer_store_dwordx2 v[32:33], v24, s[52:55], s37 offen
    s_barrier
    ds_read_b64_tr_b16 v[34:35], v23 offset:23552
    s_mov_b32 s37, 524288
    s_waitcnt lgkmcnt(0)
    buffer_store_dwordx2 v[34:35], v24, s[52:55], s37 offen
    s_cmp_gt_u32 s24, 0
    s_cbranch_scc1 L_hA1
    v_add_u32 v26, 13960, v21
    v_add_u32 v27, 16064, v21
    v_add_u32 v28, 18176, v21
    v_add_u32 v29, 20288, v21
    v_mov_b32 v112, s72
    v_mov_b32 v113, s73
    v_mov_b32 v114, s74
    v_mov_b32 v115, s75
    v_mov_b32 v116, s76
    v_mov_b32 v117, s77
    s_waitcnt vmcnt(3)
    s_nop 1
    v_mov_b32_dpp v112, v120 wave_shr:1 row_mask:0xf bank_mask:0xf
    v_mov_b32_dpp v113, v121 wave_shr:1 row_mask:0xf bank_mask:0xf
    v_mov_b32_dpp v114, v122 wave_shr:1 row_mask:0xf bank_mask:0xf
    v_mov_b32_dpp v115, v123 wave_shr:1 row_mask:0xf bank_mask:0xf
    v_mov_b32_dpp v116, v124 wave_shr:1 row_mask:0xf bank_mask:0xf
    v_mov_b32_dpp v117, v125 wave_shr:1 row_mask:0xf bank_mask:0xf
    v_perm_b32 v44, v120, v118, s48
    v_perm_b32 v45, v124, v122, s48
    v_perm_b32 v46, v120, v118, s49
    v_perm_b32 v47, v124, v122, s49
    ds_write2st64_b64 v26, v[44:45], v[46:47] offset0:0 offset1:80
    v_perm_b32 v48, v114, v112, s48
    v_perm_b32 v49, v118, v116, s48
    v_perm_b32 v50, v114, v112, s49
    v_perm_b32 v51, v118, v116, s49
    ds_write2st64_b64 v27, v[48:49], v[50:51] offset0:0 offset1:80
    v_perm_b32 v52, v116, v114, s48
    v_perm_b32 v53, v120, v118, s48
    v_perm_b32 v54, v116, v114, s49
    v_perm_b32 v55, v120, v118, s49
    ds_write2st64_b64 v28, v[52:53], v[54:55] offset0:0 offset1:80
    v_perm_b32 v56, v118, v116, s48
    v_perm_b32 v57, v122, v120, s48
    v_perm_b32 v58, v118, v116, s49
    v_perm_b32 v59, v122, v120, s49
    ds_write2st64_b64 v29, v[56:57], v[58:59] offset0:0 offset1:80
    v_perm_b32 v44, v121, v119, s48
    v_perm_b32 v45, v125, v123, s48
    v_perm_b32 v46, v121, v119, s49
    v_perm_b32 v47, v125, v123, s49
    ds_write2st64_b64 v26, v[44:45], v[46:47] offset0:160 offset1:240
    v_perm_b32 v48, v115, v113, s48
    v_perm_b32 v49, v119, v117, s48
    v_perm_b32 v50, v115, v113, s49
    v_perm_b32 v51, v119, v117, s49
    ds_write2st64_b64 v27, v[48:49], v[50:51] offset0:160 offset1:240
    v_perm_b32 v52, v117, v115, s48
    v_perm_b32 v53, v121, v119, s48
    v_perm_b32 v54, v117, v115, s49
    v_perm_b32 v55, v121, v119, s49
    ds_write2st64_b64 v28, v[52:53], v[54:55] offset0:160 offset1:240
    v_perm_b32 v56, v119, v117, s48
    v_perm_b32 v57, v123, v121, s48
    v_perm_b32 v58, v119, v117, s49
    v_perm_b32 v59, v123, v121, s49
    ds_write2st64_b64 v29, v[56:57], v[58:59] offset0:160 offset1:240
    s_waitcnt lgkmcnt(0)
L_hA1:
    s_barrier
    s_barrier
    ds_read_b64_tr_b16 v[36:37], v23 offset:24128
    s_mov_b32 s37, 786432
    s_waitcnt lgkmcnt(0)
    buffer_store_dwordx2 v[36:37], v24, s[52:55], s37 offen
    s_barrier
    ds_read_b64_tr_b16 v[38:39], v23 offset:24704
    s_mov_b32 s37, 1048576
    s_waitcnt lgkmcnt(0)
    buffer_store_dwordx2 v[38:39], v24, s[52:55], s37 offen
    s_branch L_hfin
L_hB:
    s_setprio 3
    v_add_u32 v26, 13960, v21
    v_add_u32 v27, 16064, v21
    v_add_u32 v28, 18176, v21
    v_add_u32 v29, 20288, v21
    v_mov_b32 v112, s72
    v_mov_b32 v113, s73
    v_mov_b32 v114, s74
    v_mov_b32 v115, s75
    v_mov_b32 v116, s76
    v_mov_b32 v117, s77
    s_waitcnt vmcnt(0)
    s_nop 1
    v_mov_b32_dpp v112, v120 wave_shr:1 row_mask:0xf bank_mask:0xf
    v_mov_b32_dpp v113, v121 wave_shr:1 row_mask:0xf bank_mask:0xf
    v_mov_b32_dpp v114, v122 wave_shr:1 row_mask:0xf bank_mask:0xf
    v_mov_b32_dpp v115, v123 wave_shr:1 row_mask:0xf bank_mask:0xf
    v_mov_b32_dpp v116, v124 wave_shr:1 row_mask:0xf bank_mask:0xf
    v_mov_b32_dpp v117, v125 wave_shr:1 row_mask:0xf bank_mask:0xf
    v_perm_b32 v44, v120, v118, s48
    v_perm_b32 v45, v124, v122, s48
    v_perm_b32 v46, v120, v118, s49
    v_perm_b32 v47, v124, v122, s49
    ds_write2st64_b64 v26, v[44:45], v[46:47] offset0:0 offset1:80
    v_perm_b32 v48, v114, v112, s48
    v_perm_b32 v49, v118, v116, s48
    v_perm_b32 v50, v114, v112, s49
    v_perm_b32 v51, v118, v116, s49
    ds_write2st64_b64 v27, v[48:49], v[50:51] offset0:0 offset1:80
    v_perm_b32 v52, v116, v114, s48
    v_perm_b32 v53, v120, v118, s48
    v_perm_b32 v54, v116, v114, s49
    v_perm_b32 v55, v120, v118, s49
    ds_write2st64_b64 v28, v[52:53], v[54:55] offset0:0 offset1:80
    v_perm_b32 v56, v118, v116, s48
    v_perm_b32 v57, v122, v120, s48
    v_perm_b32 v58, v118, v116, s49
    v_perm_b32 v59, v122, v120, s49
    ds_write2st64_b64 v29, v[56:57], v[58:59] offset0:0 offset1:80
    v_perm_b32 v44, v121, v119, s48
    v_perm_b32 v45, v125, v123, s48
    v_perm_b32 v46, v121, v119, s49
    v_perm_b32 v47, v125, v123, s49
    ds_write2st64_b64 v26, v[44:45], v[46:47] offset0:160 offset1:240
    v_perm_b32 v48, v115, v113, s48
    v_perm_b32 v49, v119, v117, s48
    v_perm_b32 v50, v115, v113, s49
    v_perm_b32 v51, v119, v117, s49
    ds_write2st64_b64 v27, v[48:49], v[50:51] offset0:160 offset1:240
    v_perm_b32 v52, v117, v115, s48
    v_perm_b32 v53, v121, v119, s48
    v_perm_b32 v54, v117, v115, s49
    v_perm_b32 v55, v121, v119, s49
    ds_write2st64_b64 v28, v[52:53], v[54:55] offset0:160 offset1:240
    v_perm_b32 v56, v119, v117, s48
    v_perm_b32 v57, v123, v121, s48
    v_perm_b32 v58, v119, v117, s49
    v_perm_b32 v59, v123, v121, s49
    ds_write2st64_b64 v29, v[56:57], v[58:59] offset0:160 offset1:240
L_skipl:
    s_waitcnt lgkmcnt(0)
    s_barrier
    s_barrier
    ds_read_b64_tr_b16 v[30:31], v23 offset:22400
    s_mov_b32 s37, 1310720
    s_waitcnt lgkmcnt(0)
    buffer_store_dwordx2 v[30:31], v24, s[52:55], s37 offen
    s_barrier
    ds_read_b64_tr_b16 v[32:33], v23 offset:22976
    s_mov_b32 s37, 1572864
    s_waitcnt lgkmcnt(0)
    buffer_store_dwordx2 v[32:33], v24, s[52:55], s37 offen
    s_barrier
    ds_read_b64_tr_b16 v[34:35], v23 offset:23552
    s_mov_b32 s37, 1835008
    s_waitcnt lgkmcnt(0)
    buffer_store_dwordx2 v[34:35], v24, s[52:55], s37 offen
L_hfin:
L_end:
    s_endpgm
L_codeend:

.section .rodata,"a"
.p2align 6
.amdhsa_kernel standalone__ssm_conv_s4d__prompt_kernel
  .amdhsa_next_free_vgpr 168
  .amdhsa_next_free_sgpr 96
  .amdhsa_accum_offset 168
  .amdhsa_group_segment_fixed_size 0
  .amdhsa_kernarg_size 80
  .amdhsa_user_sgpr_count 2
  .amdhsa_user_sgpr_kernarg_segment_ptr 1
  .amdhsa_system_sgpr_workgroup_id_x 1
.end_amdhsa_kernel
```
